```python
import torch

def _softmax(x, axis=-1):
    return torch.softmax(x, dim=axis)
def _gelu(x):
    return torch.nn.functional.gelu(x, approximate="tanh")
def _silu(x):
    return torch.nn.functional.silu(x)
def _sigmoid(x):
    return torch.sigmoid(x)
def _layernorm(x, axis=-1, eps=1e-5):
    m = x.mean(dim=axis, keepdim=True)
    v = x.var(dim=axis, keepdim=True, unbiased=False)
    return (x - m) / torch.sqrt(v + eps)
def _scatter_add(tgt, idx, src, axis=0):
    return tgt.clone().index_add_(axis, idx, src)
def _segment_sum(src, seg, n):
    out = torch.zeros((n,) + src.shape[1:], dtype=src.dtype)
    return out.index_add_(0, seg, src)
def _pad(x, pw):
    flat = tuple(v for pair in reversed(pw) for v in pair)
    return torch.nn.functional.pad(x, flat)

kernel_name = 'recurrent_scan__ssm_conv_s5__swiglu_ffn__prompt'

def setup_inputs():

    _w = (lambda a: (lambda t: t.to(torch.bfloat16) if t.is_floating_point() else t)(torch.as_tensor(a)))
    def _A_setup():
        B, S, D = 1, 2048, 448
        P = D
        Lambda_re = -0.5 * (lambda _x: torch.exp(torch.as_tensor(_x)))((lambda *s: torch.randn(*s, dtype=torch.bfloat16) * 0.2)(P))
        Lambda_im = (lambda *s: torch.randn(*s, dtype=torch.bfloat16) * 0.4)(P) * 1.0
        B_re = (lambda *s: torch.randn(*s, dtype=torch.bfloat16) * 0.2)(P, D) * (D ** -0.5)
        B_im = (lambda *s: torch.randn(*s, dtype=torch.bfloat16) * 0.2)(P, D) * (D ** -0.5)
        C_re = (lambda *s: torch.randn(*s, dtype=torch.bfloat16) * 0.2)(D, P) * (P ** -0.5)
        C_im = (lambda *s: torch.randn(*s, dtype=torch.bfloat16) * 0.2)(D, P) * (P ** -0.5)
        log_dt = (lambda *s: torch.randn(*s, dtype=torch.bfloat16) * 0.2)(P) * 0.3 - 2.0
        Dskip = (lambda *s: torch.randn(*s, dtype=torch.bfloat16) * 0.05)(D)
        return {
            "x": _w((lambda *s: torch.randn(*s, dtype=torch.bfloat16) * 0.05)(B, S, D)),
            "Lambda_re": _w(Lambda_re),
            "Lambda_im": _w(Lambda_im),
            "B_re": _w(B_re),
            "B_im": _w(B_im),
            "C_re": _w(C_re),
            "C_im": _w(C_im),
            "log_dt": _w(log_dt),
            "Dskip": _w(Dskip),
        }
    _A_in = _A_setup()

    def _B_setup():
        B, S, D, F = 1, 2048, 448, 1792
        return {
            "x": _w((lambda *s: torch.randn(*s, dtype=torch.bfloat16) * 0.05)(B, S, D)),
            "w_gate": _w((lambda *s: torch.randn(*s, dtype=torch.bfloat16) * 0.05)(D, F)),
            "w_up": _w((lambda *s: torch.randn(*s, dtype=torch.bfloat16) * 0.05)(D, F)),
            "w_down": _w((lambda *s: torch.randn(*s, dtype=torch.bfloat16) * 0.05)(F, D)),
        }
    _B_in = _B_setup()

    return {
        "A_x": _A_in["x"],
        "A_Lambda_re": _A_in["Lambda_re"],
        "A_Lambda_im": _A_in["Lambda_im"],
        "A_B_re": _A_in["B_re"],
        "A_B_im": _A_in["B_im"],
        "A_C_re": _A_in["C_re"],
        "A_C_im": _A_in["C_im"],
        "A_log_dt": _A_in["log_dt"],
        "A_Dskip": _A_in["Dskip"],
        "B_x": _B_in["x"],
        "B_w_gate": _B_in["w_gate"],
        "B_w_up": _B_in["w_up"],
        "B_w_down": _B_in["w_down"],
    }

def reference(A_x, A_Lambda_re, A_Lambda_im, A_B_re, A_B_im, A_C_re, A_C_im, A_log_dt, A_Dskip, B_x, B_w_gate, B_w_up, B_w_down):
    def _A_ref(x, Lambda_re, Lambda_im, B_re, B_im, C_re, C_im, log_dt, Dskip):
        Bsz, L, H = x.shape
        Lam = Lambda_re + 1j * Lambda_im
        Bmat = B_re + 1j * B_im
        Cmat = C_re + 1j * C_im
        dt = torch.exp(log_dt)
        Lam_bar = torch.exp(dt * Lam)
        B_bar = ((Lam_bar - 1.0) / Lam)[:, None] * Bmat
        Bu = torch.einsum("bld,pd->blp", x + 0j, B_bar)
        h = torch.zeros_like(Bu[:, 0, :])
        hs = []
        for t in range(L):
            h = Lam_bar[None, :] * h + Bu[:, t, :]
            hs.append(h)
        hseq = torch.stack(hs, 1)
        y = 2.0 * torch.einsum("blp,dp->bld", hseq, Cmat).real + x * Dskip[None, None, :]
        return y

    def _B_ref(x, w_gate, w_up, w_down):
        g = _silu(x @ w_gate)
        u = x @ w_up
        return (g * u) @ w_down

    x = A_x
    xn = _layernorm(x, axis=-1)
    s = _A_ref(xn, A_Lambda_re, A_Lambda_im, A_B_re, A_B_im, A_C_re, A_C_im, A_log_dt, A_Dskip)
    g = _silu(_B_ref(xn, B_w_gate, B_w_up, B_w_down))
    return x + s * g
```

```asm
; @launch grid=(256,1,1) block=(512,1,1) lds=163840
.amdgcn_target "amdgcn-amd-amdhsa--gfx950"
.text
.globl recurrent_scan__ssm_conv_s5__swiglu_ffn__prompt_kernel
.p2align 8
.type recurrent_scan__ssm_conv_s5__swiglu_ffn__prompt_kernel,@function
recurrent_scan__ssm_conv_s5__swiglu_ffn__prompt_kernel:
    s_cmp_ge_u32 s2, 256
    s_cbranch_scc1 L_END
    s_load_dwordx16 s[16:31], s[0:1], 0
    s_load_dwordx16 s[32:47], s[0:1], 64
    v_lshrrev_b32 v2, 6, v0
    v_and_b32 v1, 63, v0
    v_readfirstlane_b32 s66, v2
    s_cmp_lt_u32 s2, 32
    s_cbranch_scc1 L_SPARE
    s_and_b32 s3, s2, 7
    s_lshr_b32 s4, s2, 3
    s_sub_u32 s4, s4, 4
    s_lshr_b32 s5, s3, 1
    s_lshl_b32 s5, s5, 2
    s_and_b32 s87, s4, 3
    s_add_u32 s64, s5, s87
    s_and_b32 s5, s3, 1
    s_mul_i32 s5, s5, 7
    s_lshr_b32 s89, s4, 2
    s_add_u32 s65, s5, s89
    s_lshl_b32 s5, s3, 2
    s_add_u32 s88, s5, s87
    s_lshr_b32 s68, s66, 1
    s_lshr_b32 s69, s66, 2
    s_and_b32 s67, s66, 1
    s_xor_b32 s67, s67, s69
    s_and_b32 s70, s68, 1
    s_xor_b32 s70, s70, s69
    s_lshl_b32 s71, s67, 1
    s_add_u32 s71, s71, s70
    s_xor_b32 s72, s71, 1
    v_lshrrev_b32 v33, 3, v1
    s_lshl_b32 s3, s66, 4
    v_and_b32 v35, 7, v1
    v_add_u32 v34, s3, v33
    v_and_b32 v227, 31, v34
    v_and_b32 v226, 3, v227
    v_bfe_u32 v228, v227, 3, 2
    v_lshl_or_b32 v226, v228, 2, v226
    v_bfe_u32 v228, v227, 2, 1
    v_lshl_or_b32 v226, v228, 4, v226
    v_and_b32 v227, 0x60, v34
    v_or_b32 v226, v226, v227
    v_mul_u32_u24 v226, 896, v226
    v_bfe_u32 v34, v34, 1, 3
    v_xor_b32 v34, v34, v35
    v_lshl_add_u32 v16, v34, 4, v226
    v_add_u32 v34, s3, v33
    v_add_u32 v34, 8, v34
    v_and_b32 v227, 31, v34
    v_and_b32 v226, 3, v227
    v_bfe_u32 v228, v227, 3, 2
    v_lshl_or_b32 v226, v228, 2, v226
    v_bfe_u32 v228, v227, 2, 1
    v_lshl_or_b32 v226, v228, 4, v226
    v_and_b32 v227, 0x60, v34
    v_or_b32 v226, v226, v227
    v_mul_u32_u24 v226, 896, v226
    v_bfe_u32 v34, v34, 1, 3
    v_xor_b32 v34, v34, v35
    v_lshl_add_u32 v17, v34, 4, v226
    s_lshl_b32 s3, s66, 3
    v_add_u32 v34, s3, v33
    v_bfe_u32 v34, v34, 1, 3
    v_xor_b32 v34, v34, v35
    s_lshl_b32 s3, s65, 5
    s_lshl_b32 s5, s69, 4
    s_add_u32 s3, s3, s5
    s_and_b32 s5, s66, 1
    s_lshl_b32 s5, s5, 3
    s_add_u32 s3, s3, s5
    v_add_u32 v33, s3, v33
    v_mul_u32_u24 v33, 896, v33
    v_lshl_add_u32 v18, v34, 4, v33
    v_lshrrev_b32 v33, 4, v1
    v_and_b32 v34, 15, v1
    v_lshlrev_b32 v35, 2, v33
    v_xor_b32 v34, v34, v35
    s_lshl_b32 s3, s66, 2
    v_add_u32 v33, s3, v33
    v_mul_u32_u24 v33, 3584, v33
    v_lshl_add_u32 v19, v34, 4, v33
    s_lshl_b32 s3, s65, 8
    v_add_u32 v19, s3, v19
    s_mul_i32 s73, s64, 114688
    s_lshl_b32 s74, s66, 11
    s_lshl_b32 s75, s66, 10
    s_waitcnt lgkmcnt(0)
    s_mov_b32 s8, s16
    s_and_b32 s9, s17, 0xffff
    s_mov_b32 s10, 1835008
    s_mov_b32 s11, 0x20000
    s_mov_b32 s48, s36
    s_and_b32 s49, s37, 0xffff
    s_mov_b32 s50, 1605632
    s_mov_b32 s51, 0x20000
    s_mov_b32 s80, s38
    s_and_b32 s81, s39, 0xffff
    s_mov_b32 s82, 1605632
    s_mov_b32 s83, 0x20000
    s_and_b32 s3, s66, 2
    s_cmp_eq_u32 s3, 0
    s_cselect_b32 s56, s22, s24
    s_cselect_b32 s57, s23, s25
    s_and_b32 s57, s57, 0xffff
    s_mov_b32 s58, 401408
    s_mov_b32 s59, 0x20000
    s_movk_i32 s76, 0
    s_add_u32 m0, s74, 0
    s_add_u32 s77, s76, s73
    buffer_load_dwordx4 v16, s[8:11], s77 offen lds
    s_add_u32 m0, s74, 1024
    s_nop 0
    buffer_load_dwordx4 v17, s[8:11], s77 offen lds
    s_add_u32 m0, s75, 49152
    s_nop 0
    buffer_load_dwordx4 v18, s[56:59], s76 offen lds
    s_mov_b32 s77, 0
    s_add_u32 m0, s75, 73728
    s_nop 0
    buffer_load_dwordx4 v19, s[48:51], s77 offen  lds
    s_add_u32 m0, s75, 81920
    s_nop 0
    buffer_load_dwordx4 v19, s[80:83], s77 offen  lds
    s_mov_b32 s77, 114688
    s_add_u32 m0, s75, 90112
    s_nop 0
    buffer_load_dwordx4 v19, s[48:51], s77 offen  lds
    s_add_u32 m0, s75, 98304
    s_nop 0
    buffer_load_dwordx4 v19, s[80:83], s77 offen  lds
    s_movk_i32 s76, 128
    s_add_u32 m0, s74, 16384
    s_add_u32 s77, s76, s73
    buffer_load_dwordx4 v16, s[8:11], s77 offen lds
    s_add_u32 m0, s74, 17408
    s_nop 0
    buffer_load_dwordx4 v17, s[8:11], s77 offen lds
    s_add_u32 m0, s75, 57344
    s_nop 0
    buffer_load_dwordx4 v18, s[56:59], s76 offen lds
    s_mov_b32 s77, 229376
    s_add_u32 m0, s75, 106496
    s_nop 0
    buffer_load_dwordx4 v19, s[48:51], s77 offen  lds
    s_add_u32 m0, s75, 114688
    s_nop 0
    buffer_load_dwordx4 v19, s[80:83], s77 offen  lds
    s_mov_b32 s60, s46
    s_and_b32 s61, s47, 0xffff
    s_mov_b32 s62, 16777216
    s_mov_b32 s63, 0x20000
    s_mov_b32 s12, s44
    s_and_b32 s13, s45, 0xffff
    s_mov_b32 s14, 256
    s_mov_b32 s15, 0x20000
    v_mov_b32 v248, 0
    v_mov_b32 v249, 0
    v_mov_b32 v250, 0
    v_mov_b32 v251, 0
    v_mov_b32 v252, 0
    v_mov_b32 v253, 0
    v_mov_b32 v244, 0
    v_and_b32 v33, 31, v1
    v_lshrrev_b32 v34, 5, v1
    v_bfe_u32 v35, v33, 1, 3
    v_xor_b32 v35, v35, v34
    v_lshlrev_b32 v35, 4, v35
    v_lshl_add_u32 v35, v33, 7, v35
    s_lshl_b32 s3, s71, 12
    s_lshl_b32 s4, s72, 12
    s_lshl_b32 s5, s69, 12
    s_add_u32 s5, s5, 49152
    v_xor_b32 v226, 0, v35
    v_add_u32 v2, s3, v226
    v_add_u32 v6, s4, v226
    v_add_u32 v10, s5, v226
    v_xor_b32 v226, 32, v35
    v_add_u32 v3, s3, v226
    v_add_u32 v7, s4, v226
    v_add_u32 v11, s5, v226
    v_xor_b32 v226, 64, v35
    v_add_u32 v4, s3, v226
    v_add_u32 v8, s4, v226
    v_add_u32 v12, s5, v226
    v_xor_b32 v226, 96, v35
    v_add_u32 v5, s3, v226
    v_add_u32 v9, s4, v226
    v_add_u32 v13, s5, v226
    v_lshrrev_b32 v34, 5, v1
    v_bfe_u32 v33, v1, 2, 2
    v_lshl_add_u32 v35, v34, 3, v33
    v_lshlrev_b32 v35, 8, v35
    v_xor_b32 v33, s68, v33
    v_lshl_add_u32 v35, v33, 6, v35
    v_bfe_u32 v33, v1, 4, 1
    v_lshl_add_u32 v35, v33, 5, v35
    v_and_b32 v33, 3, v1
    v_lshl_add_u32 v35, v33, 3, v35
    v_add_u32 v14, 73728, v35
    v_add_u32 v15, 139264, v35
    s_mul_i32 s79, s65, 8192
    s_add_u32 s79, s79, 14680064
    s_mul_i32 s95, s66, 2304
    s_add_u32 s95, s95, 131072
    s_mov_b32 s92, s87
    v_lshrrev_b32 v33, 4, v1
    v_mul_u32_u24 v245, 448, v33
    v_and_b32 v34, 15, v1
    v_add_u32 v245, v245, v34
    s_lshl_b32 s4, s92, 4
    v_add_u32 v245, s4, v245
    v_mul_u32_u24 v245, 896, v245
    s_lshl_b32 s3, s89, 7
    v_add_u32 v245, s3, v245
    s_lshl_b32 s3, s89, 6
    s_add_u32 s3, s3, s4
    v_add_u32 v246, s3, v34
    v_mul_u32_u24 v246, 896, v246
    v_lshl_add_u32 v246, v33, 7, v246
    v_min_u32 v33, 2, v33
    v_add_u32 v247, s3, v34
    v_mul_u32_u24 v247, 896, v247
    v_lshl_add_u32 v247, v33, 7, v247
    v_add_u32 v247, 512, v247
    s_mov_b32 s96, s40
    s_and_b32 s97, s41, 0xffff
    s_mov_b32 s98, 0
    s_mov_b32 s99, 0x20000
    s_mov_b32 s52, s26
    s_and_b32 s53, s27, 0xffff
    s_mov_b32 s54, 0
    s_mov_b32 s55, 0x20000
    s_mov_b32 s84, s28
    s_and_b32 s85, s29, 0xffff
    s_mov_b32 s86, 0
    s_mov_b32 s87, 0x20000
    v_mov_b32 v33, 162816
    v_mov_b32 v220, 0
    v_mov_b32 v221, 0
    ds_write_b64 v33, v[220:221]
    s_waitcnt vmcnt(7)
    s_waitcnt lgkmcnt(0)
    s_barrier
    ds_read_b64_tr_b16 v[44:45], v14 offset:0
    ds_read_b64_tr_b16 v[46:47], v14 offset:1024
    ds_read_b128 v[36:39], v2 offset:0
    ds_read_b128 v[40:43], v6 offset:0
    ds_read_b64_tr_b16 v[48:49], v14 offset:8192
    ds_read_b64_tr_b16 v[50:51], v14 offset:9216
    ds_read_b128 v[52:55], v10 offset:0
    s_waitcnt lgkmcnt(4)
    v_mfma_f32_32x32x16_bf16 v[76:91], v[44:47], v[36:39], 0
    ds_read_b64_tr_b16 v[64:65], v14 offset:4096
    ds_read_b64_tr_b16 v[66:67], v14 offset:5120
    ds_read_b128 v[56:59], v3 offset:0
    s_waitcnt lgkmcnt(6)
    v_mfma_f32_32x32x16_bf16 v[92:107], v[44:47], v[40:43], 0
    ds_read_b128 v[60:63], v7 offset:0
    ds_read_b64_tr_b16 v[68:69], v14 offset:12288
    ds_read_b64_tr_b16 v[70:71], v14 offset:13312
    s_waitcnt lgkmcnt(7)
    v_mfma_f32_32x32x16_bf16 v[108:123], v[48:51], v[36:39], 0
    ds_read_b128 v[72:75], v11 offset:0
    v_mfma_f32_32x32x16_bf16 v[124:139], v[48:51], v[40:43], 0
    s_waitcnt lgkmcnt(7)
    v_mfma_f32_32x32x16_bf16 v[140:155], v[36:39], v[52:55], 0
    s_waitcnt lgkmcnt(4)
    v_mfma_f32_32x32x16_bf16 v[76:91], v[64:67], v[56:59], v[76:91]
    s_waitcnt vmcnt(5)
    s_barrier
    ds_read_b64_tr_b16 v[44:45], v14 offset:16384
    ds_read_b64_tr_b16 v[46:47], v14 offset:17408
    ds_read_b128 v[36:39], v4 offset:0
    s_waitcnt lgkmcnt(6)
    v_mfma_f32_32x32x16_bf16 v[92:107], v[64:67], v[60:63], v[92:107]
    ds_read_b128 v[40:43], v8 offset:0
    ds_read_b64_tr_b16 v[48:49], v14 offset:24576
    ds_read_b64_tr_b16 v[50:51], v14 offset:25600
    s_waitcnt lgkmcnt(7)
    v_mfma_f32_32x32x16_bf16 v[108:123], v[68:71], v[56:59], v[108:123]
    ds_read_b128 v[52:55], v12 offset:0
    s_mov_b32 s77, 344064
    s_add_u32 m0, s75, 122880
    s_nop 0
    buffer_load_dwordx4 v19, s[48:51], s77 offen  lds
    s_add_u32 m0, s75, 131072
    s_nop 0
    buffer_load_dwordx4 v19, s[80:83], s77 offen  lds
    v_mfma_f32_32x32x16_bf16 v[124:139], v[68:71], v[60:63], v[124:139]
    s_movk_i32 s76, 256
    s_add_u32 m0, s74, 32768
    s_add_u32 s77, s76, s73
    buffer_load_dwordx4 v16, s[8:11], s77 offen lds
    s_add_u32 m0, s74, 33792
    s_nop 0
    buffer_load_dwordx4 v17, s[8:11], s77 offen lds
    s_add_u32 m0, s75, 65536
    s_nop 0
    buffer_load_dwordx4 v18, s[56:59], s76 offen lds
    s_waitcnt lgkmcnt(7)
    v_mfma_f32_32x32x16_bf16 v[140:155], v[56:59], v[72:75], v[140:155]
    s_waitcnt lgkmcnt(4)
    v_mfma_f32_32x32x16_bf16 v[76:91], v[44:47], v[36:39], v[76:91]
    ds_read_b64_tr_b16 v[64:65], v14 offset:20480
    ds_read_b64_tr_b16 v[66:67], v14 offset:21504
    ds_read_b128 v[56:59], v5 offset:0
    s_waitcnt lgkmcnt(6)
    v_mfma_f32_32x32x16_bf16 v[92:107], v[44:47], v[40:43], v[92:107]
    ds_read_b128 v[60:63], v9 offset:0
    ds_read_b64_tr_b16 v[68:69], v14 offset:28672
    ds_read_b64_tr_b16 v[70:71], v14 offset:29696
    v_lshrrev_b32 v20, 4, v1
    v_lshl_add_u32 v20, s71, 2, v20
    v_and_b32 v240, 15, v1
    s_waitcnt lgkmcnt(7)
    v_mfma_f32_32x32x16_bf16 v[108:123], v[48:51], v[36:39], v[108:123]
    ds_read_b128 v[72:75], v13 offset:0
    v_lshlrev_b32 v213, 4, v240
    v_lshl_add_u32 v213, s69, 8, v213
    v_lshlrev_b32 v210, 3, v240
    v_mfma_f32_32x32x16_bf16 v[124:139], v[48:51], v[40:43], v[124:139]
    v_lshl_add_u32 v210, s69, 7, v210
    v_add_u32 v210, 155648, v210
    v_lshl_add_u32 v215, v20, 8, v210
    s_waitcnt lgkmcnt(7)
    v_mfma_f32_32x32x16_bf16 v[140:155], v[36:39], v[52:55], v[140:155]
    s_waitcnt lgkmcnt(4)
    v_mfma_f32_32x32x16_bf16 v[76:91], v[64:67], v[56:59], v[76:91]
    s_waitcnt vmcnt(5)
    s_barrier
    ds_read_b64_tr_b16 v[44:45], v14 offset:32768
    ds_read_b64_tr_b16 v[46:47], v14 offset:33792
    ds_read_b128 v[36:39], v2 offset:16384
    s_waitcnt lgkmcnt(6)
    v_mfma_f32_32x32x16_bf16 v[92:107], v[64:67], v[60:63], v[92:107]
    ds_read_b128 v[40:43], v6 offset:16384
    ds_read_b64_tr_b16 v[48:49], v14 offset:40960
    ds_read_b64_tr_b16 v[50:51], v14 offset:41984
    v_lshl_add_u32 v218, s71, 10, v210
    v_and_b32 v241, 31, v1
    v_lshlrev_b32 v211, 3, v241
    s_waitcnt lgkmcnt(7)
    v_mfma_f32_32x32x16_bf16 v[108:123], v[68:71], v[56:59], v[108:123]
    ds_read_b128 v[52:55], v10 offset:8192
    s_mov_b32 s77, 458752
    s_add_u32 m0, s75, 139264
    s_nop 0
    buffer_load_dwordx4 v19, s[48:51], s77 offen  lds
    s_add_u32 m0, s75, 147456
    s_nop 0
    buffer_load_dwordx4 v19, s[80:83], s77 offen  lds
    s_mov_b32 s77, 573440
    s_add_u32 m0, s75, 73728
    s_nop 0
    buffer_load_dwordx4 v19, s[48:51], s77 offen  lds
    s_add_u32 m0, s75, 81920
    s_nop 0
    buffer_load_dwordx4 v19, s[80:83], s77 offen  lds
    v_mfma_f32_32x32x16_bf16 v[124:139], v[68:71], v[60:63], v[124:139]
    s_cmp_eq_u32 s66, 1
    s_mov_b32 m0, 162304
    s_cselect_b32 s98, 1605632, 0
    s_mov_b32 s3, 0
    buffer_load_dword v245, s[96:99], s3 offen lds
    s_waitcnt lgkmcnt(7)
    v_mfma_f32_32x32x16_bf16 v[140:155], v[56:59], v[72:75], v[140:155]
    s_waitcnt lgkmcnt(4)
    v_mfma_f32_32x32x16_bf16 v[76:91], v[44:47], v[36:39], v[76:91]
    ds_read_b64_tr_b16 v[64:65], v14 offset:36864
    ds_read_b64_tr_b16 v[66:67], v14 offset:37888
    ds_read_b128 v[56:59], v3 offset:16384
    s_waitcnt lgkmcnt(6)
    v_mfma_f32_32x32x16_bf16 v[92:107], v[44:47], v[40:43], v[92:107]
    ds_read_b128 v[60:63], v7 offset:16384
    ds_read_b64_tr_b16 v[68:69], v14 offset:45056
    ds_read_b64_tr_b16 v[70:71], v14 offset:46080
    v_add_u32 v211, 155648, v211
    v_lshlrev_b32 v212, 4, v241
    v_lshlrev_b32 v214, 4, v1
    s_waitcnt lgkmcnt(7)
    v_mfma_f32_32x32x16_bf16 v[108:123], v[48:51], v[36:39], v[108:123]
    ds_read_b128 v[72:75], v11 offset:8192
    v_mul_u32_u24 v216, 72, v240
    v_bfe_u32 v241, v1, 4, 1
    v_lshl_add_u32 v216, v241, 5, v216
    v_mfma_f32_32x32x16_bf16 v[124:139], v[48:51], v[40:43], v[124:139]
    v_lshrrev_b32 v242, 5, v1
    v_lshl_add_u32 v216, v242, 3, v216
    v_add_u32 v216, s95, v216
    s_waitcnt lgkmcnt(7)
    v_mfma_f32_32x32x16_bf16 v[140:155], v[36:39], v[52:55], v[140:155]
    s_waitcnt lgkmcnt(4)
    v_mfma_f32_32x32x16_bf16 v[76:91], v[64:67], v[56:59], v[76:91]
    s_waitcnt vmcnt(8)
    s_barrier
    ds_read_b64_tr_b16 v[44:45], v14 offset:49152
    ds_read_b64_tr_b16 v[46:47], v14 offset:50176
    ds_read_b128 v[36:39], v4 offset:16384
    s_waitcnt lgkmcnt(6)
    v_mfma_f32_32x32x16_bf16 v[92:107], v[64:67], v[60:63], v[92:107]
    ds_read_b128 v[40:43], v8 offset:16384
    ds_read_b64_tr_b16 v[48:49], v14 offset:57344
    ds_read_b64_tr_b16 v[50:51], v14 offset:58368
    v_bfe_u32 v217, v1, 2, 2
    v_lshl_add_u32 v217, v242, 3, v217
    v_mul_u32_u24 v217, 72, v217
    s_waitcnt lgkmcnt(7)
    v_mfma_f32_32x32x16_bf16 v[108:123], v[68:71], v[56:59], v[108:123]
    ds_read_b128 v[52:55], v12 offset:8192
    s_mov_b32 s77, 688128
    s_add_u32 m0, s75, 90112
    s_nop 0
    buffer_load_dwordx4 v19, s[48:51], s77 offen  lds
    s_add_u32 m0, s75, 98304
    s_nop 0
    buffer_load_dwordx4 v19, s[80:83], s77 offen  lds
    v_mfma_f32_32x32x16_bf16 v[124:139], v[68:71], v[60:63], v[124:139]
    s_movk_i32 s76, 384
    s_add_u32 m0, s74, 0
    s_add_u32 s77, s76, s73
    buffer_load_dwordx4 v16, s[8:11], s77 offen lds
    s_add_u32 m0, s74, 1024
    s_nop 0
    buffer_load_dwordx4 v17, s[8:11], s77 offen lds
    s_add_u32 m0, s75, 49152
    s_nop 0
    buffer_load_dwordx4 v18, s[56:59], s76 offen lds
    v_and_b32 v33, 15, v1
    s_lshl_b32 s3, s65, 5
    s_lshl_b32 s4, s69, 4
    s_add_u32 s4, s3, s4
    v_add_u32 v33, s4, v33
    v_lshlrev_b32 v33, 1, v33
    v_and_b32 v34, 31, v1
    v_add_u32 v34, s3, v34
    v_lshlrev_b32 v34, 1, v34
    global_load_ushort v230, v33, s[18:19]
    global_load_ushort v233, v34, s[18:19]
    global_load_ushort v231, v33, s[20:21]
    global_load_ushort v234, v34, s[20:21]
    global_load_ushort v232, v33, s[30:31]
    global_load_ushort v235, v34, s[30:31]
    s_cmp_eq_u32 s66, 4
    s_mov_b32 m0, 162304
    s_cselect_b32 s54, 401408, 0
    buffer_load_dword v246, s[52:55], 0 offen lds
    s_waitcnt lgkmcnt(7)
    v_mfma_f32_32x32x16_bf16 v[140:155], v[56:59], v[72:75], v[140:155]
    s_waitcnt lgkmcnt(4)
    v_mfma_f32_32x32x16_bf16 v[76:91], v[44:47], v[36:39], v[76:91]
    ds_read_b64_tr_b16 v[64:65], v14 offset:53248
    ds_read_b64_tr_b16 v[66:67], v14 offset:54272
    ds_read_b128 v[56:59], v5 offset:16384
    s_waitcnt lgkmcnt(6)
    v_mfma_f32_32x32x16_bf16 v[92:107], v[44:47], v[40:43], v[92:107]
    ds_read_b128 v[60:63], v9 offset:16384
    ds_read_b64_tr_b16 v[68:69], v14 offset:61440
    ds_read_b64_tr_b16 v[70:71], v14 offset:62464
    v_lshl_add_u32 v217, v241, 5, v217
    v_and_b32 v242, 3, v1
    v_lshl_add_u32 v217, v242, 3, v217
    s_waitcnt lgkmcnt(7)
    v_mfma_f32_32x32x16_bf16 v[108:123], v[48:51], v[36:39], v[108:123]
    ds_read_b128 v[72:75], v13 offset:8192
    v_add_u32 v217, s95, v217
    v_mfma_f32_32x32x16_bf16 v[124:139], v[48:51], v[40:43], v[124:139]
    s_waitcnt lgkmcnt(7)
    v_mfma_f32_32x32x16_bf16 v[140:155], v[36:39], v[52:55], v[140:155]
    s_waitcnt lgkmcnt(4)
    v_mfma_f32_32x32x16_bf16 v[76:91], v[64:67], v[56:59], v[76:91]
    s_waitcnt vmcnt(15)
    s_barrier
    ds_read_b64_tr_b16 v[44:45], v15 offset:0
    ds_read_b64_tr_b16 v[46:47], v15 offset:1024
    ds_read_b128 v[36:39], v2 offset:32768
    s_waitcnt lgkmcnt(6)
    v_mfma_f32_32x32x16_bf16 v[92:107], v[64:67], v[60:63], v[92:107]
    ds_read_b128 v[40:43], v6 offset:32768
    ds_read_b64_tr_b16 v[48:49], v15 offset:8192
    ds_read_b64_tr_b16 v[50:51], v15 offset:9216
    s_waitcnt lgkmcnt(7)
    v_mfma_f32_32x32x16_bf16 v[108:123], v[68:71], v[56:59], v[108:123]
    ds_read_b128 v[52:55], v10 offset:16384
    s_mov_b32 s77, 802816
    s_add_u32 m0, s75, 106496
    s_nop 0
    buffer_load_dwordx4 v19, s[48:51], s77 offen  lds
    s_add_u32 m0, s75, 114688
    s_nop 0
    buffer_load_dwordx4 v19, s[80:83], s77 offen  lds
    v_mfma_f32_32x32x16_bf16 v[124:139], v[68:71], v[60:63], v[124:139]
    s_cmp_eq_u32 s66, 7
    s_mov_b32 m0, 162304
    s_cselect_b32 s86, 401408, 0
    buffer_load_dword v246, s[84:87], 0 offen lds
    s_waitcnt lgkmcnt(7)
    v_mfma_f32_32x32x16_bf16 v[140:155], v[56:59], v[72:75], v[140:155]
    s_waitcnt lgkmcnt(4)
    v_mfma_f32_32x32x16_bf16 v[76:91], v[44:47], v[36:39], v[76:91]
    ds_read_b64_tr_b16 v[64:65], v15 offset:4096
    ds_read_b64_tr_b16 v[66:67], v15 offset:5120
    ds_read_b128 v[56:59], v3 offset:32768
    s_waitcnt lgkmcnt(6)
    v_mfma_f32_32x32x16_bf16 v[92:107], v[44:47], v[40:43], v[92:107]
    ds_read_b128 v[60:63], v7 offset:32768
    ds_read_b64_tr_b16 v[68:69], v15 offset:12288
    ds_read_b64_tr_b16 v[70:71], v15 offset:13312
    s_waitcnt lgkmcnt(7)
    v_mfma_f32_32x32x16_bf16 v[108:123], v[48:51], v[36:39], v[108:123]
    ds_read_b128 v[72:75], v11 offset:16384
    v_mfma_f32_32x32x16_bf16 v[124:139], v[48:51], v[40:43], v[124:139]
    s_waitcnt lgkmcnt(7)
    v_mfma_f32_32x32x16_bf16 v[140:155], v[36:39], v[52:55], v[140:155]
    s_waitcnt lgkmcnt(4)
    v_mfma_f32_32x32x16_bf16 v[76:91], v[64:67], v[56:59], v[76:91]
    s_waitcnt vmcnt(4)
    s_barrier
    ds_read_b64_tr_b16 v[44:45], v14 offset:0
    ds_read_b64_tr_b16 v[46:47], v14 offset:1024
    ds_read_b128 v[36:39], v4 offset:32768
    s_waitcnt lgkmcnt(6)
    v_mfma_f32_32x32x16_bf16 v[92:107], v[64:67], v[60:63], v[92:107]
    ds_read_b128 v[40:43], v8 offset:32768
    ds_read_b64_tr_b16 v[48:49], v14 offset:8192
    ds_read_b64_tr_b16 v[50:51], v14 offset:9216
    s_waitcnt lgkmcnt(7)
    v_mfma_f32_32x32x16_bf16 v[108:123], v[68:71], v[56:59], v[108:123]
    ds_read_b128 v[52:55], v12 offset:16384
    s_mov_b32 s77, 917504
    s_add_u32 m0, s75, 122880
    s_nop 0
    buffer_load_dwordx4 v19, s[48:51], s77 offen  lds
    s_add_u32 m0, s75, 131072
    s_nop 0
    buffer_load_dwordx4 v19, s[80:83], s77 offen  lds
    v_mfma_f32_32x32x16_bf16 v[124:139], v[68:71], v[60:63], v[124:139]
    s_movk_i32 s76, 512
    s_add_u32 m0, s74, 16384
    s_add_u32 s77, s76, s73
    buffer_load_dwordx4 v16, s[8:11], s77 offen lds
    s_add_u32 m0, s74, 17408
    s_nop 0
    buffer_load_dwordx4 v17, s[8:11], s77 offen lds
    s_add_u32 m0, s75, 57344
    s_nop 0
    buffer_load_dwordx4 v18, s[56:59], s76 offen lds
    s_cmp_eq_u32 s66, 2
    s_mov_b32 m0, 162304
    s_cselect_b32 s98, 1605632, 0
    s_mov_b32 s3, 57344
    buffer_load_dword v245, s[96:99], s3 offen lds
    s_waitcnt lgkmcnt(7)
    v_mfma_f32_32x32x16_bf16 v[140:155], v[56:59], v[72:75], v[140:155]
    s_waitcnt lgkmcnt(4)
    v_mfma_f32_32x32x16_bf16 v[76:91], v[44:47], v[36:39], v[76:91]
    ds_read_b64_tr_b16 v[64:65], v14 offset:4096
    ds_read_b64_tr_b16 v[66:67], v14 offset:5120
    ds_read_b128 v[56:59], v5 offset:32768
    s_waitcnt lgkmcnt(6)
    v_mfma_f32_32x32x16_bf16 v[92:107], v[44:47], v[40:43], v[92:107]
    ds_read_b128 v[60:63], v9 offset:32768
    ds_read_b64_tr_b16 v[68:69], v14 offset:12288
    ds_read_b64_tr_b16 v[70:71], v14 offset:13312
    v_lshlrev_b32 v230, 16, v230
    v_lshlrev_b32 v231, 16, v231
    v_lshlrev_b32 v232, 16, v232
    s_waitcnt lgkmcnt(7)
    v_mfma_f32_32x32x16_bf16 v[108:123], v[48:51], v[36:39], v[108:123]
    ds_read_b128 v[72:75], v13 offset:16384
    v_lshlrev_b32 v233, 16, v233
    v_lshlrev_b32 v234, 16, v234
    v_lshlrev_b32 v235, 16, v235
    v_mfma_f32_32x32x16_bf16 v[124:139], v[48:51], v[40:43], v[124:139]
    v_mul_f32 v232, 1069066811, v232
    v_exp_f32 v232, v232
    s_nop 0
    v_cvt_pk_bf16_f32 v232, 0, v232
    s_waitcnt lgkmcnt(7)
    v_mfma_f32_32x32x16_bf16 v[140:155], v[36:39], v[52:55], v[140:155]
    s_waitcnt lgkmcnt(4)
    v_mfma_f32_32x32x16_bf16 v[76:91], v[64:67], v[56:59], v[76:91]
    s_barrier
    ds_read_b64_tr_b16 v[44:45], v14 offset:16384
    ds_read_b64_tr_b16 v[46:47], v14 offset:17408
    ds_read_b128 v[36:39], v2 offset:0
    s_waitcnt lgkmcnt(6)
    v_mfma_f32_32x32x16_bf16 v[92:107], v[64:67], v[60:63], v[92:107]
    ds_read_b128 v[40:43], v6 offset:0
    ds_read_b64_tr_b16 v[48:49], v14 offset:24576
    ds_read_b64_tr_b16 v[50:51], v14 offset:25600
    v_mul_f32 v236, v232, v230
    v_mul_f32 v236, 1069066811, v236
    v_mul_f32 v237, v232, v231
    s_waitcnt lgkmcnt(7)
    v_mfma_f32_32x32x16_bf16 v[108:123], v[68:71], v[56:59], v[108:123]
    ds_read_b128 v[52:55], v10 offset:0
    s_mov_b32 s77, 1032192
    s_add_u32 m0, s75, 139264
    s_nop 0
    buffer_load_dwordx4 v19, s[48:51], s77 offen  lds
    s_add_u32 m0, s75, 147456
    s_nop 0
    buffer_load_dwordx4 v19, s[80:83], s77 offen  lds
    v_mfma_f32_32x32x16_bf16 v[124:139], v[68:71], v[60:63], v[124:139]
    s_cmp_eq_u32 s66, 5
    s_mov_b32 m0, 162304
    s_cselect_b32 s98, 1605632, 0
    s_mov_b32 s3, 114688
    buffer_load_dword v245, s[96:99], s3 offen lds
    s_waitcnt lgkmcnt(7)
    v_mfma_f32_32x32x16_bf16 v[140:155], v[56:59], v[72:75], v[140:155]
    s_waitcnt lgkmcnt(4)
    v_mfma_f32_32x32x16_bf16 v[76:91], v[44:47], v[36:39], v[76:91]
    ds_read_b64_tr_b16 v[64:65], v14 offset:20480
    ds_read_b64_tr_b16 v[66:67], v14 offset:21504
    ds_read_b128 v[56:59], v3 offset:0
    s_waitcnt lgkmcnt(6)
    v_mfma_f32_32x32x16_bf16 v[92:107], v[44:47], v[40:43], v[92:107]
    ds_read_b128 v[60:63], v7 offset:0
    ds_read_b64_tr_b16 v[68:69], v14 offset:28672
    ds_read_b64_tr_b16 v[70:71], v14 offset:29696
    v_mul_f32 v237, 1042479491, v237
    v_mul_f32 v235, 1069066811, v235
    v_exp_f32 v235, v235
    s_waitcnt lgkmcnt(7)
    v_mfma_f32_32x32x16_bf16 v[108:123], v[48:51], v[36:39], v[108:123]
    ds_read_b128 v[72:75], v11 offset:0
    v_cvt_pk_bf16_f32 v235, 0, v235
    v_mul_f32 v238, v235, v233
    v_mul_f32 v238, 1069066811, v238
    v_mfma_f32_32x32x16_bf16 v[124:139], v[48:51], v[40:43], v[124:139]
    v_mul_f32 v239, v235, v234
    v_mul_f32 v239, 1042479491, v239
    v_mul_f32 v240, 1.0, v236
    s_waitcnt lgkmcnt(7)
    v_mfma_f32_32x32x16_bf16 v[140:155], v[36:39], v[52:55], v[140:155]
    s_waitcnt lgkmcnt(4)
    v_mfma_f32_32x32x16_bf16 v[76:91], v[64:67], v[56:59], v[76:91]
    s_waitcnt vmcnt(10)
    s_barrier
    ds_read_b64_tr_b16 v[44:45], v14 offset:32768
    ds_read_b64_tr_b16 v[46:47], v14 offset:33792
    ds_read_b128 v[36:39], v4 offset:0
    s_waitcnt lgkmcnt(6)
    v_mfma_f32_32x32x16_bf16 v[92:107], v[64:67], v[60:63], v[92:107]
    ds_read_b128 v[40:43], v8 offset:0
    ds_read_b64_tr_b16 v[48:49], v14 offset:40960
    ds_read_b64_tr_b16 v[50:51], v14 offset:41984
    v_mul_f32 v241, 1.0, v237
    v_exp_f32 v240, v240
    v_rndne_f32 v242, v241
    s_waitcnt lgkmcnt(7)
    v_mfma_f32_32x32x16_bf16 v[108:123], v[68:71], v[56:59], v[108:123]
    ds_read_b128 v[52:55], v12 offset:0
    s_mov_b32 s77, 1146880
    s_add_u32 m0, s75, 73728
    s_nop 0
    buffer_load_dwordx4 v19, s[48:51], s77 offen  lds
    s_add_u32 m0, s75, 81920
    s_nop 0
    buffer_load_dwordx4 v19, s[80:83], s77 offen  lds
    v_mfma_f32_32x32x16_bf16 v[124:139], v[68:71], v[60:63], v[124:139]
    s_movk_i32 s76, 640
    s_add_u32 m0, s74, 32768
    s_add_u32 s77, s76, s73
    buffer_load_dwordx4 v16, s[8:11], s77 offen lds
    s_add_u32 m0, s74, 33792
    s_nop 0
    buffer_load_dwordx4 v17, s[8:11], s77 offen lds
    s_add_u32 m0, s75, 65536
    s_nop 0
    buffer_load_dwordx4 v18, s[56:59], s76 offen lds
    s_cmp_eq_u32 s66, 0
    s_mov_b32 m0, 162304
    s_cselect_b32 s98, 1605632, 0
    s_mov_b32 s3, 172032
    buffer_load_dword v245, s[96:99], s3 offen lds
    s_waitcnt lgkmcnt(7)
    v_mfma_f32_32x32x16_bf16 v[140:155], v[56:59], v[72:75], v[140:155]
    s_waitcnt lgkmcnt(4)
    v_mfma_f32_32x32x16_bf16 v[76:91], v[44:47], v[36:39], v[76:91]
    ds_read_b64_tr_b16 v[64:65], v14 offset:36864
    ds_read_b64_tr_b16 v[66:67], v14 offset:37888
    ds_read_b128 v[56:59], v5 offset:0
    s_waitcnt lgkmcnt(6)
    v_mfma_f32_32x32x16_bf16 v[92:107], v[44:47], v[40:43], v[92:107]
    ds_read_b128 v[60:63], v9 offset:0
    ds_read_b64_tr_b16 v[68:69], v14 offset:45056
    ds_read_b64_tr_b16 v[70:71], v14 offset:46080
    v_sub_f32 v241, v241, v242
    v_cos_f32 v21, v241
    v_sin_f32 v22, v241
    s_waitcnt lgkmcnt(7)
    v_mfma_f32_32x32x16_bf16 v[108:123], v[48:51], v[36:39], v[108:123]
    ds_read_b128 v[72:75], v13 offset:0
    v_mul_f32 v21, v21, v240
    v_mul_f32 v22, v22, v240
    v_mul_f32 v240, 0x41000000, v236
    v_mfma_f32_32x32x16_bf16 v[124:139], v[48:51], v[40:43], v[124:139]
    v_mul_f32 v241, 0x41000000, v237
    v_exp_f32 v240, v240
    v_rndne_f32 v242, v241
    s_waitcnt lgkmcnt(7)
    v_mfma_f32_32x32x16_bf16 v[140:155], v[36:39], v[52:55], v[140:155]
    s_waitcnt lgkmcnt(4)
    v_mfma_f32_32x32x16_bf16 v[76:91], v[64:67], v[56:59], v[76:91]
    s_waitcnt vmcnt(10)
    s_barrier
    ds_read_b64_tr_b16 v[44:45], v14 offset:49152
    ds_read_b64_tr_b16 v[46:47], v14 offset:50176
    ds_read_b128 v[36:39], v2 offset:16384
    s_waitcnt lgkmcnt(6)
    v_mfma_f32_32x32x16_bf16 v[92:107], v[64:67], v[60:63], v[92:107]
    ds_read_b128 v[40:43], v6 offset:16384
    ds_read_b64_tr_b16 v[48:49], v14 offset:57344
    ds_read_b64_tr_b16 v[50:51], v14 offset:58368
    v_sub_f32 v241, v241, v242
    v_cos_f32 v25, v241
    v_sin_f32 v26, v241
    s_waitcnt lgkmcnt(7)
    v_mfma_f32_32x32x16_bf16 v[108:123], v[68:71], v[56:59], v[108:123]
    ds_read_b128 v[52:55], v10 offset:8192
    s_mov_b32 s77, 1261568
    s_add_u32 m0, s75, 90112
    s_nop 0
    buffer_load_dwordx4 v19, s[48:51], s77 offen  lds
    s_add_u32 m0, s75, 98304
    s_nop 0
    buffer_load_dwordx4 v19, s[80:83], s77 offen  lds
    v_mfma_f32_32x32x16_bf16 v[124:139], v[68:71], v[60:63], v[124:139]
    s_cmp_eq_u32 s66, 3
    s_mov_b32 m0, 162304
    s_cselect_b32 s54, 401408, 0
    buffer_load_dword v247, s[52:55], 0 offen lds
    s_waitcnt lgkmcnt(7)
    v_mfma_f32_32x32x16_bf16 v[140:155], v[56:59], v[72:75], v[140:155]
    s_waitcnt lgkmcnt(4)
    v_mfma_f32_32x32x16_bf16 v[76:91], v[44:47], v[36:39], v[76:91]
    ds_read_b64_tr_b16 v[64:65], v14 offset:53248
    ds_read_b64_tr_b16 v[66:67], v14 offset:54272
    ds_read_b128 v[56:59], v3 offset:16384
    s_waitcnt lgkmcnt(6)
    v_mfma_f32_32x32x16_bf16 v[92:107], v[44:47], v[40:43], v[92:107]
    ds_read_b128 v[60:63], v7 offset:16384
    ds_read_b64_tr_b16 v[68:69], v14 offset:61440
    ds_read_b64_tr_b16 v[70:71], v14 offset:62464
    v_mul_f32 v25, v25, v240
    v_mul_f32 v26, v26, v240
    v_mul_f32 v240, 0x43000000, v238
    s_waitcnt lgkmcnt(7)
    v_mfma_f32_32x32x16_bf16 v[108:123], v[48:51], v[36:39], v[108:123]
    ds_read_b128 v[72:75], v11 offset:8192
    v_mul_f32 v241, 0x43000000, v239
    v_exp_f32 v240, v240
    v_rndne_f32 v242, v241
    v_mfma_f32_32x32x16_bf16 v[124:139], v[48:51], v[40:43], v[124:139]
    v_sub_f32 v241, v241, v242
    v_cos_f32 v31, v241
    v_sin_f32 v32, v241
    s_waitcnt lgkmcnt(7)
    v_mfma_f32_32x32x16_bf16 v[140:155], v[36:39], v[52:55], v[140:155]
    s_waitcnt lgkmcnt(4)
    v_mfma_f32_32x32x16_bf16 v[76:91], v[64:67], v[56:59], v[76:91]
    s_waitcnt vmcnt(10)
    s_barrier
    ds_read_b64_tr_b16 v[44:45], v15 offset:0
    ds_read_b64_tr_b16 v[46:47], v15 offset:1024
    ds_read_b128 v[36:39], v4 offset:16384
    s_waitcnt lgkmcnt(6)
    v_mfma_f32_32x32x16_bf16 v[92:107], v[64:67], v[60:63], v[92:107]
    ds_read_b128 v[40:43], v8 offset:16384
    ds_read_b64_tr_b16 v[48:49], v15 offset:8192
    ds_read_b64_tr_b16 v[50:51], v15 offset:9216
    v_mul_f32 v31, v31, v240
    v_mul_f32 v32, v32, v240
    v_lshlrev_b32 v243, 3, v20
    s_waitcnt lgkmcnt(7)
    v_mfma_f32_32x32x16_bf16 v[108:123], v[68:71], v[56:59], v[108:123]
    ds_read_b128 v[52:55], v12 offset:8192
    s_mov_b32 s77, 1376256
    s_add_u32 m0, s75, 106496
    s_nop 0
    buffer_load_dwordx4 v19, s[48:51], s77 offen  lds
    s_add_u32 m0, s75, 114688
    s_nop 0
    buffer_load_dwordx4 v19, s[80:83], s77 offen  lds
    v_mfma_f32_32x32x16_bf16 v[124:139], v[68:71], v[60:63], v[124:139]
    s_movk_i32 s76, 768
    s_add_u32 m0, s74, 0
    s_add_u32 s77, s76, s73
    buffer_load_dwordx4 v16, s[8:11], s77 offen lds
    s_add_u32 m0, s74, 1024
    s_nop 0
    buffer_load_dwordx4 v17, s[8:11], s77 offen lds
    s_add_u32 m0, s75, 49152
    s_nop 0
    buffer_load_dwordx4 v18, s[56:59], s76 offen lds
    s_cmp_eq_u32 s66, 6
    s_mov_b32 m0, 162304
    s_cselect_b32 s86, 401408, 0
    buffer_load_dword v247, s[84:87], 0 offen lds
    s_waitcnt lgkmcnt(7)
    v_mfma_f32_32x32x16_bf16 v[140:155], v[56:59], v[72:75], v[140:155]
    s_waitcnt lgkmcnt(4)
    v_mfma_f32_32x32x16_bf16 v[76:91], v[44:47], v[36:39], v[76:91]
    ds_read_b64_tr_b16 v[64:65], v15 offset:4096
    ds_read_b64_tr_b16 v[66:67], v15 offset:5120
    ds_read_b128 v[56:59], v5 offset:16384
    s_waitcnt lgkmcnt(6)
    v_mfma_f32_32x32x16_bf16 v[92:107], v[44:47], v[40:43], v[92:107]
    ds_read_b128 v[60:63], v9 offset:16384
    ds_read_b64_tr_b16 v[68:69], v15 offset:12288
    ds_read_b64_tr_b16 v[70:71], v15 offset:13312
    v_cvt_f32_u32 v243, v243
    v_mul_f32 v240, v243, v236
    v_mul_f32 v241, v243, v237
    s_waitcnt lgkmcnt(7)
    v_mfma_f32_32x32x16_bf16 v[108:123], v[48:51], v[36:39], v[108:123]
    ds_read_b128 v[72:75], v13 offset:8192
    v_exp_f32 v240, v240
    v_rndne_f32 v242, v241
    v_sub_f32 v241, v241, v242
    v_mfma_f32_32x32x16_bf16 v[124:139], v[48:51], v[40:43], v[124:139]
    v_cos_f32 v27, v241
    v_sin_f32 v28, v241
    v_mul_f32 v27, v27, v240
    s_waitcnt lgkmcnt(7)
    v_mfma_f32_32x32x16_bf16 v[140:155], v[36:39], v[52:55], v[140:155]
    s_waitcnt lgkmcnt(4)
    v_mfma_f32_32x32x16_bf16 v[76:91], v[64:67], v[56:59], v[76:91]
    s_waitcnt vmcnt(10)
    s_barrier
    ds_read_b64_tr_b16 v[44:45], v14 offset:0
    ds_read_b64_tr_b16 v[46:47], v14 offset:1024
    ds_read_b128 v[36:39], v2 offset:32768
    s_waitcnt lgkmcnt(6)
    v_mfma_f32_32x32x16_bf16 v[92:107], v[64:67], v[60:63], v[92:107]
    ds_read_b128 v[40:43], v6 offset:32768
    ds_read_b64_tr_b16 v[48:49], v14 offset:8192
    ds_read_b64_tr_b16 v[50:51], v14 offset:9216
    v_mul_f32 v28, v28, v240
    v_add_f32 v240, -1.0, v21
    v_mul_f32 v241, v230, v230
    s_waitcnt lgkmcnt(7)
    v_mfma_f32_32x32x16_bf16 v[108:123], v[68:71], v[56:59], v[108:123]
    ds_read_b128 v[52:55], v10 offset:16384
    s_mov_b32 s77, 1490944
    s_add_u32 m0, s75, 122880
    s_nop 0
    buffer_load_dwordx4 v19, s[48:51], s77 offen  lds
    s_add_u32 m0, s75, 131072
    s_nop 0
    buffer_load_dwordx4 v19, s[80:83], s77 offen  lds
    v_mfma_f32_32x32x16_bf16 v[124:139], v[68:71], v[60:63], v[124:139]
    s_cmp_eq_u32 s66, 1
    s_mov_b32 m0, 162304
    s_cselect_b32 s98, 1605632, 0
    s_mov_b32 s3, 229376
    buffer_load_dword v245, s[96:99], s3 offen lds
    s_waitcnt lgkmcnt(7)
    v_mfma_f32_32x32x16_bf16 v[140:155], v[56:59], v[72:75], v[140:155]
    s_waitcnt lgkmcnt(4)
    v_mfma_f32_32x32x16_bf16 v[76:91], v[44:47], v[36:39], v[76:91]
    ds_read_b64_tr_b16 v[64:65], v14 offset:4096
    ds_read_b64_tr_b16 v[66:67], v14 offset:5120
    ds_read_b128 v[56:59], v3 offset:32768
    s_waitcnt lgkmcnt(6)
    v_mfma_f32_32x32x16_bf16 v[92:107], v[44:47], v[40:43], v[92:107]
    ds_read_b128 v[60:63], v7 offset:32768
    ds_read_b64_tr_b16 v[68:69], v14 offset:12288
    ds_read_b64_tr_b16 v[70:71], v14 offset:13312
    v_fmac_f32 v241, v231, v231
    v_rcp_f32 v241, v241
    s_nop 0
    v_add_f32 v241, v241, v241
    s_waitcnt lgkmcnt(7)
    v_mfma_f32_32x32x16_bf16 v[108:123], v[48:51], v[36:39], v[108:123]
    ds_read_b128 v[72:75], v11 offset:16384
    v_mul_f32 v242, v240, v230
    v_fmac_f32 v242, v22, v231
    v_mul_f32 v23, v242, v241
    v_mfma_f32_32x32x16_bf16 v[124:139], v[48:51], v[40:43], v[124:139]
    v_mul_f32 v242, v22, v230
    v_fma_f32 v242, -v240, v231, v242
    v_mul_f32 v24, v242, v241
    s_waitcnt lgkmcnt(7)
    v_mfma_f32_32x32x16_bf16 v[140:155], v[36:39], v[52:55], v[140:155]
    s_waitcnt lgkmcnt(4)
    v_mfma_f32_32x32x16_bf16 v[76:91], v[64:67], v[56:59], v[76:91]
    s_waitcnt vmcnt(10)
    s_barrier
    ds_read_b64_tr_b16 v[44:45], v14 offset:16384
    ds_read_b64_tr_b16 v[46:47], v14 offset:17408
    ds_read_b128 v[36:39], v4 offset:32768
    s_waitcnt lgkmcnt(6)
    v_mfma_f32_32x32x16_bf16 v[92:107], v[64:67], v[60:63], v[92:107]
    ds_read_b128 v[40:43], v8 offset:32768
    ds_read_b64_tr_b16 v[48:49], v14 offset:24576
    ds_read_b64_tr_b16 v[50:51], v14 offset:25600
    v_lshrrev_b32 v230, 5, v1
    v_lshlrev_b32 v230, 4, v230
    v_add_u32 v230, 155648, v230
    s_waitcnt lgkmcnt(7)
    v_mfma_f32_32x32x16_bf16 v[108:123], v[68:71], v[56:59], v[108:123]
    ds_read_b128 v[52:55], v12 offset:16384
    v_mfma_f32_32x32x16_bf16 v[124:139], v[68:71], v[60:63], v[124:139]
    s_cmp_eq_u32 s66, 4
    s_mov_b32 m0, 162304
    s_cselect_b32 s98, 1605632, 0
    s_mov_b32 s3, 286720
    buffer_load_dword v245, s[96:99], s3 offen lds
    s_cmp_lg_u32 s66, 7
    s_cbranch_scc1 L_NC
    s_mov_b64 exec, 0xff
    v_lshlrev_b32 v244, 4, v1
    buffer_load_dwordx4 v[220:223], v244, s[12:15], 0 offen offset:128 sc1
    s_mov_b64 exec, -1
L_NC:
    s_waitcnt lgkmcnt(7)
    v_mfma_f32_32x32x16_bf16 v[140:155], v[56:59], v[72:75], v[140:155]
    s_waitcnt lgkmcnt(4)
    v_mfma_f32_32x32x16_bf16 v[76:91], v[44:47], v[36:39], v[76:91]
    ds_read_b64_tr_b16 v[64:65], v14 offset:20480
    ds_read_b64_tr_b16 v[66:67], v14 offset:21504
    ds_read_b128 v[56:59], v5 offset:32768
    s_waitcnt lgkmcnt(6)
    v_mfma_f32_32x32x16_bf16 v[92:107], v[44:47], v[40:43], v[92:107]
    ds_read_b128 v[60:63], v9 offset:32768
    ds_read_b64_tr_b16 v[68:69], v14 offset:28672
    ds_read_b64_tr_b16 v[70:71], v14 offset:29696
    v_bfe_u32 v231, v1, 4, 1
    v_lshl_add_u32 v231, v231, 6, v230
    v_lshl_add_u32 v231, s71, 7, v231
    s_waitcnt lgkmcnt(7)
    v_mfma_f32_32x32x16_bf16 v[108:123], v[48:51], v[36:39], v[108:123]
    ds_read_b128 v[72:75], v13 offset:16384
    v_lshl_add_u32 v230, s68, 7, v230
    v_and_b32 v232, 31, v1
    v_lshlrev_b32 v232, 2, v232
    v_mfma_f32_32x32x16_bf16 v[124:139], v[48:51], v[40:43], v[124:139]
    v_add_u32 v232, 155648, v232
    v_lshl_add_u32 v233, s72, 7, v232
    v_lshl_add_u32 v232, s71, 7, v232
    s_waitcnt lgkmcnt(7)
    v_mfma_f32_32x32x16_bf16 v[140:155], v[36:39], v[52:55], v[140:155]
    s_waitcnt lgkmcnt(4)
    v_mfma_f32_32x32x16_bf16 v[76:91], v[64:67], v[56:59], v[76:91]
    s_waitcnt vmcnt(5)
    s_cmp_lg_u32 s66, 7
    s_cbranch_scc1 L_PCHK_OK
    s_mov_b32 s93, 0
    s_mov_b64 exec, 0xff
    s_waitcnt vmcnt(0)
L_PCHK:
    v_and_b32 v220, v220, v221
    v_and_b32 v222, v222, v223
    v_and_b32 v220, v220, v222
    v_cmp_ne_u32 vcc, 1, v220
    s_nop 1
    s_cmp_eq_u32 vcc_lo, 0
    s_cbranch_scc1 L_PCHK_D
    buffer_load_dwordx4 v[220:223], v244, s[12:15], 0 offen offset:128 sc1
    s_waitcnt vmcnt(0)
    s_add_u32 s93, s93, 1
    s_cmp_lt_u32 s93, 0x40000
    s_cbranch_scc1 L_PCHK
L_PCHK_D:
    s_mov_b64 exec, -1
L_PCHK_OK:
    s_barrier
    ds_read_b64_tr_b16 v[44:45], v14 offset:32768
    ds_read_b64_tr_b16 v[46:47], v14 offset:33792
    ds_read_b128 v[36:39], v2 offset:0
    s_waitcnt lgkmcnt(6)
    v_mfma_f32_32x32x16_bf16 v[92:107], v[64:67], v[60:63], v[92:107]
    ds_read_b128 v[40:43], v6 offset:0
    ds_read_b64_tr_b16 v[48:49], v14 offset:40960
    ds_read_b64_tr_b16 v[50:51], v14 offset:41984
    v_and_b32 v234, 15, v1
    v_lshl_add_u32 v234, s69, 4, v234
    v_lshlrev_b32 v234, 2, v234
    s_waitcnt lgkmcnt(7)
    v_mfma_f32_32x32x16_bf16 v[108:123], v[68:71], v[56:59], v[108:123]
    ds_read_b128 v[52:55], v10 offset:0
    v_mfma_f32_32x32x16_bf16 v[124:139], v[68:71], v[60:63], v[124:139]
    s_cmp_eq_u32 s66, 7
    s_mov_b32 m0, 162304
    s_cselect_b32 s98, 1605632, 0
    s_mov_b32 s3, 344064
    buffer_load_dword v245, s[96:99], s3 offen lds
    v_lshlrev_b32 v33, 4, v1
    s_lshl_b32 s3, s65, 9
    s_add_u32 s3, s3, 14974976
    s_mov_b32 s4, 160000
    s_cmp_eq_u32 s66, 1
    s_cselect_b32 s5, 7168, 0
    s_cselect_b32 s4, 160512, s4
    s_add_u32 s3, s3, s5
    s_lshl_b32 s5, s64, 9
    s_add_u32 s5, s5, 14942208
    s_cmp_eq_u32 s66, 3
    s_cselect_b32 s3, s5, s3
    s_cselect_b32 s4, 161280, s4
    s_add_u32 s5, s5, 8192
    s_cmp_ge_u32 s66, 4
    s_cselect_b32 s3, s5, s3
    s_cselect_b32 s4, 161792, s4
    s_mov_b64 exec, 0xffffffff
    s_cmp_lg_u32 s66, 2
    s_cbranch_scc1 L_FD1
    s_lshl_b32 s3, s65, 7
    s_add_u32 s3, s3, 14989312
    s_mov_b32 s4, 161024
    v_bfe_u32 v34, v1, 3, 1
    v_mul_u32_u24 v34, 1664, v34
    v_add_u32 v33, v33, v34
    s_mov_b64 exec, 0xffff
L_FD1:
    s_mov_b32 m0, s4
    s_nop 0
    buffer_load_dwordx4 v33, s[60:63], s3 offen sc1 lds
    s_mov_b64 exec, -1
    s_waitcnt lgkmcnt(7)
    v_mfma_f32_32x32x16_bf16 v[140:155], v[56:59], v[72:75], v[140:155]
    s_waitcnt lgkmcnt(4)
    v_mfma_f32_32x32x16_bf16 v[76:91], v[44:47], v[36:39], v[76:91]
    ds_read_b64_tr_b16 v[64:65], v14 offset:36864
    ds_read_b64_tr_b16 v[66:67], v14 offset:37888
    ds_read_b128 v[56:59], v3 offset:0
    s_waitcnt lgkmcnt(6)
    v_mfma_f32_32x32x16_bf16 v[92:107], v[44:47], v[40:43], v[92:107]
    ds_read_b128 v[60:63], v7 offset:0
    ds_read_b64_tr_b16 v[68:69], v14 offset:45056
    ds_read_b64_tr_b16 v[70:71], v14 offset:46080
    v_add_u32 v234, 155648, v234
    s_waitcnt lgkmcnt(7)
    v_mfma_f32_32x32x16_bf16 v[108:123], v[48:51], v[36:39], v[108:123]
    ds_read_b128 v[72:75], v11 offset:0
    v_mfma_f32_32x32x16_bf16 v[124:139], v[48:51], v[40:43], v[124:139]
    s_waitcnt lgkmcnt(7)
    v_mfma_f32_32x32x16_bf16 v[140:155], v[36:39], v[52:55], v[140:155]
    s_waitcnt lgkmcnt(4)
    v_mfma_f32_32x32x16_bf16 v[76:91], v[64:67], v[56:59], v[76:91]
    s_waitcnt vmcnt(0)
    s_barrier
    ds_read_b64_tr_b16 v[44:45], v14 offset:49152
    ds_read_b64_tr_b16 v[46:47], v14 offset:50176
    ds_read_b128 v[36:39], v4 offset:0
    s_waitcnt lgkmcnt(6)
    v_mfma_f32_32x32x16_bf16 v[92:107], v[64:67], v[60:63], v[92:107]
    ds_read_b128 v[40:43], v8 offset:0
    ds_read_b64_tr_b16 v[48:49], v14 offset:57344
    ds_read_b64_tr_b16 v[50:51], v14 offset:58368
    s_waitcnt lgkmcnt(7)
    v_mfma_f32_32x32x16_bf16 v[108:123], v[68:71], v[56:59], v[108:123]
    ds_read_b128 v[52:55], v12 offset:0
    ds_read_b128 v[188:191], v231 offset:5632
    ds_read_b128 v[192:195], v231 offset:5664
    ds_read_b32 v208, v234 offset:5376
    ds_read_b32 v209, v234 offset:5504
    ds_read_b128 v[196:199], v231 offset:6144
    ds_read_b128 v[200:203], v231 offset:6176
    v_mfma_f32_32x32x16_bf16 v[124:139], v[68:71], v[60:63], v[124:139]
    s_lshl_b32 s90, s66, 14
    s_mov_b32 s55, 0x20000
    s_cmp_ge_u32 s66, 5
    s_cbranch_scc1 L_PS4
    s_mov_b32 s52, s40
    s_and_b32 s53, s41, 0xffff
    s_mov_b32 s54, 1605632
    s_mul_i32 s94, s66, 22
    s_min_u32 s3, s66, 2
    s_add_u32 s94, s94, s3
    s_mul_i32 s91, s94, 14336
    v_lshrrev_b32 v248, 3, v1
    v_bfe_u32 v33, v1, 4, 1
    v_lshlrev_b32 v33, 2, v33
    v_and_b32 v34, 7, v1
    v_xor_b32 v33, v33, v34
    v_mul_u32_u24 v248, 896, v248
    v_lshl_add_u32 v248, v33, 4, v248
    s_lshl_b32 s3, s89, 7
    v_add_u32 v248, s3, v248
    v_bfe_u32 v33, v1, 2, 2
    v_lshrrev_b32 v35, 5, v1
    v_lshl_add_u32 v35, v35, 2, v33
    v_lshlrev_b32 v35, 7, v35
    v_bfe_u32 v33, v1, 3, 1
    v_lshl_add_u32 v35, v33, 6, v35
    v_bfe_u32 v33, v1, 4, 1
    v_lshl_add_u32 v35, v33, 5, v35
    v_and_b32 v33, 3, v1
    v_lshl_add_u32 v35, v33, 3, v35
    v_add_u32 v250, s90, v35
    v_xor_b32 v35, 64, v35
    v_add_u32 v251, s90, v35
    s_branch L_PS9
L_PS4:
    s_mov_b32 s54, 401408
    s_sub_u32 s91, s66, 5
    s_mul_i32 s91, s91, 5
    s_lshl_b32 s94, s91, 2
    v_lshrrev_b32 v33, 3, v1
    s_lshl_b32 s3, s89, 6
    v_add_u32 v33, s3, v33
    v_mul_u32_u24 v33, 896, v33
    v_lshrrev_b32 v34, 4, v1
    v_and_b32 v35, 7, v1
    v_xor_b32 v34, v34, v35
    v_lshl_add_u32 v248, v34, 4, v33
    v_xor_b32 v34, 4, v34
    v_lshl_add_u32 v249, v34, 4, v33
    v_and_b32 v33, 31, v1
    v_lshrrev_b32 v34, 5, v1
    v_bfe_u32 v35, v33, 1, 3
    v_xor_b32 v35, v35, v34
    v_lshlrev_b32 v35, 4, v35
    v_lshl_add_u32 v35, v33, 7, v35
    v_xor_b32 v226, 0, v35
    v_add_u32 v250, s90, v226
    v_xor_b32 v226, 32, v35
    v_add_u32 v251, s90, v226
    v_xor_b32 v226, 64, v35
    v_add_u32 v252, s90, v226
    v_xor_b32 v226, 96, v35
    v_add_u32 v253, s90, v226
L_PS9:
    s_waitcnt lgkmcnt(13)
    v_mfma_f32_32x32x16_bf16 v[140:155], v[56:59], v[72:75], v[140:155]
    s_waitcnt lgkmcnt(10)
    v_mfma_f32_32x32x16_bf16 v[76:91], v[44:47], v[36:39], v[76:91]
    ds_read_b64_tr_b16 v[64:65], v14 offset:53248
    ds_read_b64_tr_b16 v[66:67], v14 offset:54272
    ds_read_b128 v[56:59], v5 offset:0
    s_waitcnt lgkmcnt(12)
    v_mfma_f32_32x32x16_bf16 v[92:107], v[44:47], v[40:43], v[92:107]
    ds_read_b128 v[60:63], v9 offset:0
    ds_read_b64_tr_b16 v[68:69], v14 offset:61440
    ds_read_b64_tr_b16 v[70:71], v14 offset:62464
    s_waitcnt lgkmcnt(13)
    v_mfma_f32_32x32x16_bf16 v[108:123], v[48:51], v[36:39], v[108:123]
    ds_read_b128 v[72:75], v13 offset:0
    ds_read_b32 v204, v232 offset:5632
    ds_read_b32 v205, v232 offset:6144
    ds_read_b32 v206, v233 offset:5632
    ds_read_b32 v207, v233 offset:6144
    ds_read_b128 v[156:159], v230 offset:4352
    ds_read_b128 v[172:175], v230 offset:4864
    v_mfma_f32_32x32x16_bf16 v[124:139], v[48:51], v[40:43], v[124:139]
    s_waitcnt lgkmcnt(15)
    v_mfma_f32_32x32x16_bf16 v[140:155], v[36:39], v[52:55], v[140:155]
    s_waitcnt lgkmcnt(6)
    v_mfma_f32_32x32x16_bf16 v[140:155], v[56:59], v[72:75], v[140:155]
    v_mfma_f32_32x32x16_bf16 v[76:91], v[64:67], v[56:59], v[76:91]
    v_mfma_f32_32x32x16_bf16 v[92:107], v[64:67], v[60:63], v[92:107]
    v_mfma_f32_32x32x16_bf16 v[108:123], v[68:71], v[56:59], v[108:123]
    ds_read_b128 v[160:163], v230 offset:4384
    ds_read_b128 v[176:179], v230 offset:4896
    ds_read_b128 v[164:167], v230 offset:4416
    ds_read_b128 v[180:183], v230 offset:4928
    ds_read_b128 v[168:171], v230 offset:4448
    ds_read_b128 v[184:187], v230 offset:4960
    v_mfma_f32_32x32x16_bf16 v[124:139], v[68:71], v[60:63], v[124:139]
    s_nop 1
    v_permlane16_swap_b32 v140, v148
    v_permlane16_swap_b32 v141, v149
    v_permlane16_swap_b32 v142, v150
    v_permlane16_swap_b32 v143, v151
    v_permlane16_swap_b32 v144, v152
    v_permlane16_swap_b32 v145, v153
    v_permlane16_swap_b32 v146, v154
    v_permlane16_swap_b32 v147, v155
    v_fma_f32 v140, -v188, v208, v140
    v_fma_f32 v148, -v188, v209, v148
    v_fma_f32 v141, -v189, v208, v141
    v_fma_f32 v149, -v189, v209, v149
    v_fma_f32 v142, -v190, v208, v142
    v_fma_f32 v150, -v190, v209, v150
    v_fma_f32 v143, -v191, v208, v143
    v_fma_f32 v151, -v191, v209, v151
    v_fma_f32 v144, -v192, v208, v144
    v_fma_f32 v152, -v192, v209, v152
    v_fma_f32 v145, -v193, v208, v145
    v_fma_f32 v153, -v193, v209, v153
    v_fma_f32 v146, -v194, v208, v146
    v_fma_f32 v154, -v194, v209, v154
    v_fma_f32 v147, -v195, v208, v147
    v_fma_f32 v155, -v195, v209, v155
    v_mul_f32 v140, v140, v196
    v_mul_f32 v148, v148, v196
    v_mul_f32 v141, v141, v197
    v_mul_f32 v149, v149, v197
    v_mul_f32 v142, v142, v198
    v_mul_f32 v150, v150, v198
    v_mul_f32 v143, v143, v199
    v_mul_f32 v151, v151, v199
    v_mul_f32 v144, v144, v200
    v_mul_f32 v152, v152, v200
    v_mul_f32 v145, v145, v201
    v_mul_f32 v153, v153, v201
    v_mul_f32 v146, v146, v202
    v_mul_f32 v154, v154, v202
    v_mul_f32 v147, v147, v203
    v_mul_f32 v155, v155, v203
    v_mul_f32 v188, v24, v148
    v_mul_f32 v196, v24, v140
    v_mul_f32 v189, v24, v149
    v_mul_f32 v197, v24, v141
    v_mul_f32 v190, v24, v150
    v_mul_f32 v198, v24, v142
    v_mul_f32 v191, v24, v151
    v_mul_f32 v199, v24, v143
    v_mul_f32 v192, v24, v152
    v_mul_f32 v200, v24, v144
    v_mul_f32 v193, v24, v153
    v_mul_f32 v201, v24, v145
    v_mul_f32 v194, v24, v154
    v_mul_f32 v202, v24, v146
    v_mul_f32 v195, v24, v155
    v_mul_f32 v203, v24, v147
    v_fma_f32 v140, v23, v140, -v188
    v_fmac_f32 v196, v23, v148
    v_fma_f32 v141, v23, v141, -v189
    v_fmac_f32 v197, v23, v149
    v_fma_f32 v142, v23, v142, -v190
    v_fmac_f32 v198, v23, v150
    v_fma_f32 v143, v23, v143, -v191
    v_fmac_f32 v199, v23, v151
    v_fma_f32 v144, v23, v144, -v192
    v_fmac_f32 v200, v23, v152
    v_fma_f32 v145, v23, v145, -v193
    v_fmac_f32 v201, v23, v153
    v_fma_f32 v146, v23, v146, -v194
    v_fmac_f32 v202, v23, v154
    v_fma_f32 v147, v23, v147, -v195
    v_fmac_f32 v203, v23, v155
    s_waitcnt lgkmcnt(0)
    v_fma_f32 v188, v21, v140, v141
    v_fma_f32 v189, v21, v196, v197
    v_mul_f32 v219, 3216550459, v205
    v_fma_f32 v188, -v22, v196, v188
    v_fmac_f32 v189, v22, v140
    v_mul_f32 v224, 3216550459, v207
    v_fma_f32 v190, v21, v188, v142
    v_fma_f32 v191, v21, v189, v198
    v_fma_f32 v76, -v204, v156, v76
    v_fma_f32 v190, -v22, v189, v190
    v_fmac_f32 v191, v22, v188
    v_fma_f32 v77, -v204, v157, v77
    v_fma_f32 v188, v21, v190, v143
    v_fma_f32 v189, v21, v191, v199
    v_fma_f32 v78, -v204, v158, v78
    v_fma_f32 v188, -v22, v191, v188
    v_fmac_f32 v189, v22, v190
    v_fma_f32 v79, -v204, v159, v79
    v_fma_f32 v190, v21, v188, v144
    v_fma_f32 v191, v21, v189, v200
    v_fma_f32 v80, -v204, v160, v80
    v_fma_f32 v190, -v22, v189, v190
    v_fmac_f32 v191, v22, v188
    v_fma_f32 v81, -v204, v161, v81
    v_fma_f32 v188, v21, v190, v145
    v_fma_f32 v189, v21, v191, v201
    v_fma_f32 v82, -v204, v162, v82
    v_fma_f32 v188, -v22, v191, v188
    v_fmac_f32 v189, v22, v190
    v_fma_f32 v83, -v204, v163, v83
    v_fma_f32 v190, v21, v188, v146
    v_fma_f32 v191, v21, v189, v202
    v_fma_f32 v84, -v204, v164, v84
    v_fma_f32 v190, -v22, v189, v190
    v_fmac_f32 v191, v22, v188
    v_fma_f32 v85, -v204, v165, v85
    v_fma_f32 v188, v21, v190, v147
    v_fma_f32 v189, v21, v191, v203
    v_fma_f32 v86, -v204, v166, v86
    v_fma_f32 v188, -v22, v191, v188
    v_fmac_f32 v189, v22, v190
    v_fma_f32 v87, -v204, v167, v87
    ds_write_b64 v215, v[188:189] offset:0
    v_fma_f32 v88, -v204, v168, v88
    v_fma_f32 v89, -v204, v169, v89
    v_fma_f32 v90, -v204, v170, v90
    v_fma_f32 v91, -v204, v171, v91
    s_waitcnt lgkmcnt(0)
    s_barrier
    ds_read_b64 v[36:37], v210 offset:0
    ds_read_b64 v[38:39], v210 offset:256
    ds_read_b64 v[40:41], v210 offset:512
    ds_read_b64 v[42:43], v210 offset:768
    ds_read_b64 v[44:45], v210 offset:1024
    ds_read_b64 v[46:47], v210 offset:1280
    ds_read_b64 v[48:49], v210 offset:1536
    ds_read_b64 v[50:51], v210 offset:1792
    ds_read_b64 v[52:53], v210 offset:2048
    ds_read_b64 v[54:55], v210 offset:2304
    ds_read_b64 v[56:57], v210 offset:2560
    ds_read_b64 v[58:59], v210 offset:2816
    ds_read_b64 v[60:61], v218 offset:0
    ds_read_b64 v[62:63], v218 offset:256
    ds_read_b64 v[64:65], v218 offset:512
    ds_read_b64 v[66:67], v218 offset:768
    v_fma_f32 v108, -v204, v172, v108
    v_fma_f32 v109, -v204, v173, v109
    v_fma_f32 v110, -v204, v174, v110
    v_fma_f32 v111, -v204, v175, v111
    v_fma_f32 v112, -v204, v176, v112
    v_fma_f32 v113, -v204, v177, v113
    v_fma_f32 v114, -v204, v178, v114
    v_fma_f32 v115, -v204, v179, v115
    v_fma_f32 v116, -v204, v180, v116
    v_fma_f32 v117, -v204, v181, v117
    v_fma_f32 v118, -v204, v182, v118
    v_fma_f32 v119, -v204, v183, v119
    v_fma_f32 v120, -v204, v184, v120
    v_fma_f32 v121, -v204, v185, v121
    v_fma_f32 v122, -v204, v186, v122
    v_fma_f32 v123, -v204, v187, v123
    v_mov_b32 v70, 0
    v_mov_b32 v71, 0
    s_waitcnt lgkmcnt(0)
    s_cmp_le_u32 s71, 0
    s_cbranch_scc1 L_PFX
    v_fmac_f32 v36, v25, v70
    v_fmac_f32 v37, v25, v71
    v_fma_f32 v36, -v26, v71, v36
    v_fma_f32 v71, v26, v70, v37
    v_mov_b32 v70, v36
    v_fmac_f32 v38, v25, v70
    v_fmac_f32 v39, v25, v71
    v_fma_f32 v38, -v26, v71, v38
    v_fma_f32 v71, v26, v70, v39
    v_mov_b32 v70, v38
    v_fmac_f32 v40, v25, v70
    v_fmac_f32 v41, v25, v71
    v_fma_f32 v40, -v26, v71, v40
    v_fma_f32 v71, v26, v70, v41
    v_mov_b32 v70, v40
    v_fmac_f32 v42, v25, v70
    v_fmac_f32 v43, v25, v71
    v_fma_f32 v42, -v26, v71, v42
    v_fma_f32 v71, v26, v70, v43
    v_mov_b32 v70, v42
    s_cmp_le_u32 s71, 1
    s_cbranch_scc1 L_PFX
    v_fmac_f32 v44, v25, v70
    v_fmac_f32 v45, v25, v71
    v_fma_f32 v44, -v26, v71, v44
    v_fma_f32 v71, v26, v70, v45
    v_mov_b32 v70, v44
    v_fmac_f32 v46, v25, v70
    v_fmac_f32 v47, v25, v71
    v_fma_f32 v46, -v26, v71, v46
    v_fma_f32 v71, v26, v70, v47
    v_mov_b32 v70, v46
    v_fmac_f32 v48, v25, v70
    v_fmac_f32 v49, v25, v71
    v_fma_f32 v48, -v26, v71, v48
    v_fma_f32 v71, v26, v70, v49
    v_mov_b32 v70, v48
    v_fmac_f32 v50, v25, v70
    v_fmac_f32 v51, v25, v71
    v_fma_f32 v50, -v26, v71, v50
    v_fma_f32 v71, v26, v70, v51
    v_mov_b32 v70, v50
    s_cmp_le_u32 s71, 2
    s_cbranch_scc1 L_PFX
    v_fmac_f32 v52, v25, v70
    v_fmac_f32 v53, v25, v71
    v_fma_f32 v52, -v26, v71, v52
    v_fma_f32 v71, v26, v70, v53
    v_mov_b32 v70, v52
    v_fmac_f32 v54, v25, v70
    v_fmac_f32 v55, v25, v71
    v_fma_f32 v54, -v26, v71, v54
    v_fma_f32 v71, v26, v70, v55
    v_mov_b32 v70, v54
    v_fmac_f32 v56, v25, v70
    v_fmac_f32 v57, v25, v71
    v_fma_f32 v56, -v26, v71, v56
    v_fma_f32 v71, v26, v70, v57
    v_mov_b32 v70, v56
    v_fmac_f32 v58, v25, v70
    v_fmac_f32 v59, v25, v71
    v_fma_f32 v58, -v26, v71, v58
    v_fma_f32 v71, v26, v70, v59
    v_mov_b32 v70, v58
L_PFX:
    v_lshrrev_b32 v72, 4, v1
    v_mov_b32 v68, v70
    v_mov_b32 v69, v71
    v_cmp_eq_u32 vcc, 1, v72
    v_fmac_f32 v60, v25, v70
    v_fmac_f32 v61, v25, v71
    v_fma_f32 v60, -v26, v71, v60
    v_fma_f32 v71, v26, v70, v61
    v_mov_b32 v70, v60
    v_cndmask_b32 v68, v68, v70, vcc
    v_cndmask_b32 v69, v69, v71, vcc
    v_cmp_eq_u32 vcc, 2, v72
    v_fmac_f32 v62, v25, v70
    v_fmac_f32 v63, v25, v71
    v_fma_f32 v62, -v26, v71, v62
    v_fma_f32 v71, v26, v70, v63
    v_mov_b32 v70, v62
    v_cndmask_b32 v68, v68, v70, vcc
    v_cndmask_b32 v69, v69, v71, vcc
    v_cmp_eq_u32 vcc, 3, v72
    v_fmac_f32 v64, v25, v70
    v_fmac_f32 v65, v25, v71
    v_fma_f32 v64, -v26, v71, v64
    v_fma_f32 v71, v26, v70, v65
    v_mov_b32 v70, v64
    v_cndmask_b32 v68, v68, v70, vcc
    v_cndmask_b32 v69, v69, v71, vcc
    s_cmp_lg_u32 s71, 3
    s_cbranch_scc1 L_NOPUB
    v_fmac_f32 v66, v25, v70
    v_fmac_f32 v67, v25, v71
    v_fma_f32 v66, -v26, v71, v66
    v_fma_f32 v71, v26, v70, v67
    v_mov_b32 v70, v66
    v_mov_b32 v36, v70
    v_mov_b32 v37, 1
    v_mov_b32 v38, v71
    v_mov_b32 v39, 1
    s_lshl_b32 s3, s64, 9
    s_add_u32 s3, s3, s79
    s_mov_b64 exec, 0xffff
    buffer_store_dwordx4 v[36:39], v213, s[60:63], s3 offen sc0 sc1
    s_mov_b64 exec, -1
    s_nop 1
L_NOPUB:
    v_mul_f32 v108, v108, v76
    v_mul_f32 v109, v109, v77
    v_mul_f32 v110, v110, v78
    v_mul_f32 v111, v111, v79
    v_mul_f32 v76, v219, v76
    v_mul_f32 v77, v219, v77
    v_mul_f32 v78, v219, v78
    v_mul_f32 v79, v219, v79
    v_exp_f32 v76, v76
    v_exp_f32 v77, v77
    v_exp_f32 v78, v78
    v_exp_f32 v79, v79
    v_fma_f32 v92, -v206, v156, v92
    v_fma_f32 v93, -v206, v157, v93
    v_fma_f32 v94, -v206, v158, v94
    v_fma_f32 v95, -v206, v159, v95
    v_add_f32 v76, 1.0, v76
    v_add_f32 v77, 1.0, v77
    v_add_f32 v78, 1.0, v78
    v_add_f32 v79, 1.0, v79
    v_rcp_f32 v76, v76
    v_rcp_f32 v77, v77
    v_rcp_f32 v78, v78
    v_rcp_f32 v79, v79
    v_fma_f32 v96, -v206, v160, v96
    v_fma_f32 v97, -v206, v161, v97
    v_fma_f32 v98, -v206, v162, v98
    v_fma_f32 v99, -v206, v163, v99
    s_cmp_ge_u32 s66, 5
    s_cbranch_scc1 L_ES0
    s_add_u32 m0, s90, 0
    s_add_u32 s77, s91, 0
    s_add_u32 s76, s91, 6144
    buffer_load_dwordx4 v248, s[52:55], s77 offen lds
    buffer_load_dwordx4 v248, s[52:55], s76 offen offset:1024 lds
    s_branch L_E0
L_ES0:
    s_add_u32 s76, s91, 0
    s_cmp_ge_u32 s76, 7
    s_cselect_b32 s52, s28, s26
    s_cselect_b32 s53, s29, s27
    s_cselect_b32 s77, 7, 0
    s_sub_u32 s76, s76, s77
    s_lshl_b32 s76, s76, 7
    s_and_b32 s53, s53, 0xffff
    s_add_u32 m0, s90, 0
    s_add_u32 s77, s76, 0
    buffer_load_dwordx4 v248, s[52:55], s77 offen offset:0 lds
    s_add_u32 m0, s90, 0
    s_add_u32 s77, s76, 6144
    buffer_load_dwordx4 v249, s[52:55], s77 offen offset:1024 lds
L_E0:
    v_mul_f32 v108, v108, v76
    v_mul_f32 v109, v109, v77
    v_mul_f32 v110, v110, v78
    v_mul_f32 v111, v111, v79
    v_cvt_pk_bf16_f32 v76, v108, v109
    v_cvt_pk_bf16_f32 v77, v110, v111
    v_mul_f32 v112, v112, v80
    v_mul_f32 v113, v113, v81
    v_mul_f32 v114, v114, v82
    v_mul_f32 v115, v115, v83
    v_mul_f32 v80, v219, v80
    v_mul_f32 v81, v219, v81
    v_mul_f32 v82, v219, v82
    v_mul_f32 v83, v219, v83
    v_exp_f32 v80, v80
    v_exp_f32 v81, v81
    v_exp_f32 v82, v82
    v_exp_f32 v83, v83
    v_fma_f32 v100, -v206, v164, v100
    v_fma_f32 v101, -v206, v165, v101
    v_fma_f32 v102, -v206, v166, v102
    v_fma_f32 v103, -v206, v167, v103
    v_add_f32 v80, 1.0, v80
    v_add_f32 v81, 1.0, v81
    v_add_f32 v82, 1.0, v82
    v_add_f32 v83, 1.0, v83
    v_rcp_f32 v80, v80
    v_rcp_f32 v81, v81
    v_rcp_f32 v82, v82
    v_rcp_f32 v83, v83
    v_fma_f32 v104, -v206, v168, v104
    v_fma_f32 v105, -v206, v169, v105
    v_fma_f32 v106, -v206, v170, v106
    v_fma_f32 v107, -v206, v171, v107
    s_cmp_ge_u32 s66, 5
    s_cbranch_scc1 L_ES1
    s_add_u32 m0, s90, 2048
    s_add_u32 s77, s91, 14336
    s_add_u32 s76, s91, 20480
    buffer_load_dwordx4 v248, s[52:55], s77 offen lds
    buffer_load_dwordx4 v248, s[52:55], s76 offen offset:1024 lds
    s_branch L_E1
L_ES1:
    s_add_u32 s76, s91, 0
    s_cmp_ge_u32 s76, 7
    s_cselect_b32 s52, s28, s26
    s_cselect_b32 s53, s29, s27
    s_cselect_b32 s77, 7, 0
    s_sub_u32 s76, s76, s77
    s_lshl_b32 s76, s76, 7
    s_and_b32 s53, s53, 0xffff
    s_add_u32 m0, s90, 0
    s_add_u32 s77, s76, 12288
    buffer_load_dwordx4 v248, s[52:55], s77 offen offset:2048 lds
    s_add_u32 m0, s90, 0
    s_add_u32 s77, s76, 18432
    buffer_load_dwordx4 v249, s[52:55], s77 offen offset:3072 lds
L_E1:
    v_mul_f32 v112, v112, v80
    v_mul_f32 v113, v113, v81
    v_mul_f32 v114, v114, v82
    v_mul_f32 v115, v115, v83
    v_cvt_pk_bf16_f32 v78, v112, v113
    v_cvt_pk_bf16_f32 v79, v114, v115
    v_mul_f32 v116, v116, v84
    v_mul_f32 v117, v117, v85
    v_mul_f32 v118, v118, v86
    v_mul_f32 v119, v119, v87
    v_mul_f32 v84, v219, v84
    v_mul_f32 v85, v219, v85
    v_mul_f32 v86, v219, v86
    v_mul_f32 v87, v219, v87
    v_exp_f32 v84, v84
    v_exp_f32 v85, v85
    v_exp_f32 v86, v86
    v_exp_f32 v87, v87
    v_fma_f32 v124, -v206, v172, v124
    v_fma_f32 v125, -v206, v173, v125
    v_fma_f32 v126, -v206, v174, v126
    v_fma_f32 v127, -v206, v175, v127
    v_add_f32 v84, 1.0, v84
    v_add_f32 v85, 1.0, v85
    v_add_f32 v86, 1.0, v86
    v_add_f32 v87, 1.0, v87
    v_rcp_f32 v84, v84
    v_rcp_f32 v85, v85
    v_rcp_f32 v86, v86
    v_rcp_f32 v87, v87
    v_fma_f32 v128, -v206, v176, v128
    v_fma_f32 v129, -v206, v177, v129
    v_fma_f32 v130, -v206, v178, v130
    v_fma_f32 v131, -v206, v179, v131
    s_cmp_ge_u32 s66, 5
    s_cbranch_scc1 L_ES2
    s_add_u32 m0, s90, 4096
    s_add_u32 s77, s91, 28672
    s_add_u32 s76, s91, 34816
    buffer_load_dwordx4 v248, s[52:55], s77 offen lds
    buffer_load_dwordx4 v248, s[52:55], s76 offen offset:1024 lds
    s_branch L_E2
L_ES2:
    s_add_u32 s76, s91, 0
    s_cmp_ge_u32 s76, 7
    s_cselect_b32 s52, s28, s26
    s_cselect_b32 s53, s29, s27
    s_cselect_b32 s77, 7, 0
    s_sub_u32 s76, s76, s77
    s_lshl_b32 s76, s76, 7
    s_and_b32 s53, s53, 0xffff
    s_add_u32 m0, s90, 4096
    s_add_u32 s77, s76, 28672
    buffer_load_dwordx4 v248, s[52:55], s77 offen offset:0 lds
    s_add_u32 m0, s90, 4096
    s_add_u32 s77, s76, 34816
    buffer_load_dwordx4 v249, s[52:55], s77 offen offset:1024 lds
L_E2:
    v_mul_f32 v116, v116, v84
    v_mul_f32 v117, v117, v85
    v_mul_f32 v118, v118, v86
    v_mul_f32 v119, v119, v87
    v_cvt_pk_bf16_f32 v80, v116, v117
    v_cvt_pk_bf16_f32 v81, v118, v119
    v_mul_f32 v120, v120, v88
    v_mul_f32 v121, v121, v89
    v_mul_f32 v122, v122, v90
    v_mul_f32 v123, v123, v91
    v_mul_f32 v88, v219, v88
    v_mul_f32 v89, v219, v89
    v_mul_f32 v90, v219, v90
    v_mul_f32 v91, v219, v91
    v_exp_f32 v88, v88
    v_exp_f32 v89, v89
    v_exp_f32 v90, v90
    v_exp_f32 v91, v91
    v_fma_f32 v132, -v206, v180, v132
    v_fma_f32 v133, -v206, v181, v133
    v_fma_f32 v134, -v206, v182, v134
    v_fma_f32 v135, -v206, v183, v135
    v_add_f32 v88, 1.0, v88
    v_add_f32 v89, 1.0, v89
    v_add_f32 v90, 1.0, v90
    v_add_f32 v91, 1.0, v91
    v_rcp_f32 v88, v88
    v_rcp_f32 v89, v89
    v_rcp_f32 v90, v90
    v_rcp_f32 v91, v91
    v_fma_f32 v136, -v206, v184, v136
    v_fma_f32 v137, -v206, v185, v137
    v_fma_f32 v138, -v206, v186, v138
    v_fma_f32 v139, -v206, v187, v139
    s_cmp_ge_u32 s66, 5
    s_cbranch_scc1 L_ES3
    s_add_u32 m0, s90, 6144
    s_add_u32 s77, s91, 43008
    s_add_u32 s76, s91, 49152
    buffer_load_dwordx4 v248, s[52:55], s77 offen lds
    buffer_load_dwordx4 v248, s[52:55], s76 offen offset:1024 lds
    s_branch L_E3
L_ES3:
    s_add_u32 s76, s91, 0
    s_cmp_ge_u32 s76, 7
    s_cselect_b32 s52, s28, s26
    s_cselect_b32 s53, s29, s27
    s_cselect_b32 s77, 7, 0
    s_sub_u32 s76, s76, s77
    s_lshl_b32 s76, s76, 7
    s_and_b32 s53, s53, 0xffff
    s_add_u32 m0, s90, 4096
    s_add_u32 s77, s76, 40960
    buffer_load_dwordx4 v248, s[52:55], s77 offen offset:2048 lds
    s_add_u32 m0, s90, 4096
    s_add_u32 s77, s76, 47104
    buffer_load_dwordx4 v249, s[52:55], s77 offen offset:3072 lds
L_E3:
    v_mul_f32 v120, v120, v88
    v_mul_f32 v121, v121, v89
    v_mul_f32 v122, v122, v90
    v_mul_f32 v123, v123, v91
    v_cvt_pk_bf16_f32 v82, v120, v121
    v_cvt_pk_bf16_f32 v83, v122, v123
    s_lshl_b32 s3, s64, 2
    s_add_u32 s3, s3, s71
    s_mul_i32 s3, s3, 112
    s_lshl_b32 s4, s65, 2
    s_add_u32 s4, s4, s68
    s_lshl_b32 s4, s4, 1
    s_add_u32 s3, s3, s4
    s_lshl_b32 s3, s3, 10
    s_add_u32 s3, s3, 2097152
    buffer_store_dwordx4 v[76:79], v214, s[60:63], s3 offen sc0 sc1
    buffer_store_dwordx4 v[80:83], v214, s[60:63], s3 offen offset:1024 sc0 sc1
    s_cmp_lg_u32 s66, 7
    s_cbranch_scc1 L_NOP1
    s_cmp_eq_u32 s64, 0
    s_cbranch_scc1 L_NOP1
    s_add_u32 s3, s79, 0
    buffer_load_dwordx4 v[84:87], v212, s[60:63], s3 offen offset:0 sc0 sc1
    buffer_load_dwordx4 v[88:91], v212, s[60:63], s3 offen offset:512 sc0 sc1
    buffer_load_dwordx4 v[108:111], v212, s[60:63], s3 offen offset:1024 sc0 sc1
    buffer_load_dwordx4 v[112:115], v212, s[60:63], s3 offen offset:1536 sc0 sc1
    buffer_load_dwordx4 v[116:119], v212, s[60:63], s3 offen offset:2048 sc0 sc1
    buffer_load_dwordx4 v[120:123], v212, s[60:63], s3 offen offset:2560 sc0 sc1
    buffer_load_dwordx4 v[36:39], v212, s[60:63], s3 offen offset:3072 sc0 sc1
    buffer_load_dwordx4 v[40:43], v212, s[60:63], s3 offen offset:3584 sc0 sc1
    s_add_u32 s3, s79, 4096
    buffer_load_dwordx4 v[44:47], v212, s[60:63], s3 offen offset:0 sc0 sc1
    buffer_load_dwordx4 v[48:51], v212, s[60:63], s3 offen offset:512 sc0 sc1
    buffer_load_dwordx4 v[52:55], v212, s[60:63], s3 offen offset:1024 sc0 sc1
    buffer_load_dwordx4 v[56:59], v212, s[60:63], s3 offen offset:1536 sc0 sc1
    buffer_load_dwordx4 v[60:63], v212, s[60:63], s3 offen offset:2048 sc0 sc1
    buffer_load_dwordx4 v[64:67], v212, s[60:63], s3 offen offset:2560 sc0 sc1
    buffer_load_dwordx4 v[220:223], v212, s[60:63], s3 offen offset:3072 sc0 sc1
L_NOP1:
    v_mul_f32 v124, v124, v92
    v_mul_f32 v125, v125, v93
    v_mul_f32 v126, v126, v94
    v_mul_f32 v127, v127, v95
    v_mul_f32 v92, v224, v92
    v_mul_f32 v93, v224, v93
    v_mul_f32 v94, v224, v94
    v_mul_f32 v95, v224, v95
    v_exp_f32 v92, v92
    v_exp_f32 v93, v93
    v_exp_f32 v94, v94
    v_exp_f32 v95, v95
    v_add_f32 v92, 1.0, v92
    v_add_f32 v93, 1.0, v93
    v_add_f32 v94, 1.0, v94
    v_add_f32 v95, 1.0, v95
    v_rcp_f32 v92, v92
    v_rcp_f32 v93, v93
    v_rcp_f32 v94, v94
    v_rcp_f32 v95, v95
    s_cmp_ge_u32 s66, 5
    s_cbranch_scc1 L_ES4
    s_add_u32 m0, s90, 8192
    s_add_u32 s77, s91, 57344
    s_add_u32 s76, s91, 63488
    buffer_load_dwordx4 v248, s[52:55], s77 offen lds
    buffer_load_dwordx4 v248, s[52:55], s76 offen offset:1024 lds
    s_branch L_E4
L_ES4:
    s_add_u32 s76, s91, 1
    s_cmp_ge_u32 s76, 7
    s_cselect_b32 s52, s28, s26
    s_cselect_b32 s53, s29, s27
    s_cselect_b32 s77, 7, 0
    s_sub_u32 s76, s76, s77
    s_lshl_b32 s76, s76, 7
    s_and_b32 s53, s53, 0xffff
    s_add_u32 m0, s90, 8192
    s_add_u32 s77, s76, 0
    buffer_load_dwordx4 v248, s[52:55], s77 offen offset:0 lds
    s_add_u32 m0, s90, 8192
    s_add_u32 s77, s76, 6144
    buffer_load_dwordx4 v249, s[52:55], s77 offen offset:1024 lds
L_E4:
    v_mul_f32 v124, v124, v92
    v_mul_f32 v125, v125, v93
    v_mul_f32 v126, v126, v94
    v_mul_f32 v127, v127, v95
    v_cvt_pk_bf16_f32 v92, v124, v125
    v_cvt_pk_bf16_f32 v93, v126, v127
    v_mul_f32 v128, v128, v96
    v_mul_f32 v129, v129, v97
    v_mul_f32 v130, v130, v98
    v_mul_f32 v131, v131, v99
    v_mul_f32 v96, v224, v96
    v_mul_f32 v97, v224, v97
    v_mul_f32 v98, v224, v98
    v_mul_f32 v99, v224, v99
    v_exp_f32 v96, v96
    v_exp_f32 v97, v97
    v_exp_f32 v98, v98
    v_exp_f32 v99, v99
    v_add_f32 v96, 1.0, v96
    v_add_f32 v97, 1.0, v97
    v_add_f32 v98, 1.0, v98
    v_add_f32 v99, 1.0, v99
    v_rcp_f32 v96, v96
    v_rcp_f32 v97, v97
    v_rcp_f32 v98, v98
    v_rcp_f32 v99, v99
    s_cmp_ge_u32 s66, 5
    s_cbranch_scc1 L_ES5
    s_add_u32 m0, s90, 10240
    s_add_u32 s77, s91, 71680
    s_add_u32 s76, s91, 77824
    buffer_load_dwordx4 v248, s[52:55], s77 offen lds
    buffer_load_dwordx4 v248, s[52:55], s76 offen offset:1024 lds
    s_branch L_E5
L_ES5:
    s_add_u32 s76, s91, 1
    s_cmp_ge_u32 s76, 7
    s_cselect_b32 s52, s28, s26
    s_cselect_b32 s53, s29, s27
    s_cselect_b32 s77, 7, 0
    s_sub_u32 s76, s76, s77
    s_lshl_b32 s76, s76, 7
    s_and_b32 s53, s53, 0xffff
    s_add_u32 m0, s90, 8192
    s_add_u32 s77, s76, 12288
    buffer_load_dwordx4 v248, s[52:55], s77 offen offset:2048 lds
    s_add_u32 m0, s90, 8192
    s_add_u32 s77, s76, 18432
    buffer_load_dwordx4 v249, s[52:55], s77 offen offset:3072 lds
L_E5:
    v_mul_f32 v128, v128, v96
    v_mul_f32 v129, v129, v97
    v_mul_f32 v130, v130, v98
    v_mul_f32 v131, v131, v99
    v_cvt_pk_bf16_f32 v94, v128, v129
    v_cvt_pk_bf16_f32 v95, v130, v131
    v_mul_f32 v132, v132, v100
    v_mul_f32 v133, v133, v101
    v_mul_f32 v134, v134, v102
    v_mul_f32 v135, v135, v103
    v_mul_f32 v100, v224, v100
    v_mul_f32 v101, v224, v101
    v_mul_f32 v102, v224, v102
    v_mul_f32 v103, v224, v103
    v_exp_f32 v100, v100
    v_exp_f32 v101, v101
    v_exp_f32 v102, v102
    v_exp_f32 v103, v103
    v_add_f32 v100, 1.0, v100
    v_add_f32 v101, 1.0, v101
    v_add_f32 v102, 1.0, v102
    v_add_f32 v103, 1.0, v103
    v_rcp_f32 v100, v100
    v_rcp_f32 v101, v101
    v_rcp_f32 v102, v102
    v_rcp_f32 v103, v103
    s_cmp_ge_u32 s66, 5
    s_cbranch_scc1 L_ES6
    s_add_u32 m0, s90, 12288
    s_add_u32 s77, s91, 86016
    s_add_u32 s76, s91, 92160
    buffer_load_dwordx4 v248, s[52:55], s77 offen lds
    buffer_load_dwordx4 v248, s[52:55], s76 offen offset:1024 lds
    s_branch L_E6
L_ES6:
    s_add_u32 s76, s91, 1
    s_cmp_ge_u32 s76, 7
    s_cselect_b32 s52, s28, s26
    s_cselect_b32 s53, s29, s27
    s_cselect_b32 s77, 7, 0
    s_sub_u32 s76, s76, s77
    s_lshl_b32 s76, s76, 7
    s_and_b32 s53, s53, 0xffff
    s_add_u32 m0, s90, 12288
    s_add_u32 s77, s76, 28672
    buffer_load_dwordx4 v248, s[52:55], s77 offen offset:0 lds
    s_add_u32 m0, s90, 12288
    s_add_u32 s77, s76, 34816
    buffer_load_dwordx4 v249, s[52:55], s77 offen offset:1024 lds
L_E6:
    v_mul_f32 v132, v132, v100
    v_mul_f32 v133, v133, v101
    v_mul_f32 v134, v134, v102
    v_mul_f32 v135, v135, v103
    v_cvt_pk_bf16_f32 v96, v132, v133
    v_cvt_pk_bf16_f32 v97, v134, v135
    v_mul_f32 v136, v136, v104
    v_mul_f32 v137, v137, v105
    v_mul_f32 v138, v138, v106
    v_mul_f32 v139, v139, v107
    v_mul_f32 v104, v224, v104
    v_mul_f32 v105, v224, v105
    v_mul_f32 v106, v224, v106
    v_mul_f32 v107, v224, v107
    v_exp_f32 v104, v104
    v_exp_f32 v105, v105
    v_exp_f32 v106, v106
    v_exp_f32 v107, v107
    v_add_f32 v104, 1.0, v104
    v_add_f32 v105, 1.0, v105
    v_add_f32 v106, 1.0, v106
    v_add_f32 v107, 1.0, v107
    v_rcp_f32 v104, v104
    v_rcp_f32 v105, v105
    v_rcp_f32 v106, v106
    v_rcp_f32 v107, v107
    s_cmp_ge_u32 s66, 5
    s_cbranch_scc1 L_ES7
    s_add_u32 m0, s90, 14336
    s_add_u32 s77, s91, 100352
    s_add_u32 s76, s91, 106496
    buffer_load_dwordx4 v248, s[52:55], s77 offen lds
    buffer_load_dwordx4 v248, s[52:55], s76 offen offset:1024 lds
    s_branch L_E7
L_ES7:
    s_add_u32 s76, s91, 1
    s_cmp_ge_u32 s76, 7
    s_cselect_b32 s52, s28, s26
    s_cselect_b32 s53, s29, s27
    s_cselect_b32 s77, 7, 0
    s_sub_u32 s76, s76, s77
    s_lshl_b32 s76, s76, 7
    s_and_b32 s53, s53, 0xffff
    s_add_u32 m0, s90, 12288
    s_add_u32 s77, s76, 40960
    buffer_load_dwordx4 v248, s[52:55], s77 offen offset:2048 lds
    s_add_u32 m0, s90, 12288
    s_add_u32 s77, s76, 47104
    buffer_load_dwordx4 v249, s[52:55], s77 offen offset:3072 lds
L_E7:
    v_mul_f32 v136, v136, v104
    v_mul_f32 v137, v137, v105
    v_mul_f32 v138, v138, v106
    v_mul_f32 v139, v139, v107
    v_cvt_pk_bf16_f32 v98, v136, v137
    v_cvt_pk_bf16_f32 v99, v138, v139
    s_lshl_b32 s3, s64, 2
    s_add_u32 s3, s3, s72
    s_mul_i32 s3, s3, 112
    s_lshl_b32 s4, s65, 2
    s_add_u32 s4, s4, s68
    s_lshl_b32 s4, s4, 1
    s_add_u32 s3, s3, s4
    s_lshl_b32 s3, s3, 10
    s_add_u32 s3, s3, 2097152
    buffer_store_dwordx4 v[92:95], v214, s[60:63], s3 offen sc0 sc1
    buffer_store_dwordx4 v[96:99], v214, s[60:63], s3 offen offset:1024 sc0 sc1
    s_cmp_lg_u32 s66, 7
    s_cbranch_scc1 L_NOPOLL
    v_mov_b32 v72, 0
    v_mov_b32 v73, 0
    s_mov_b32 s93, 0
    s_cmp_eq_u32 s64, 0
    s_cbranch_scc1 L_GDONE
    s_branch L_POLL1
L_POLL:
    s_add_u32 s3, s79, 0
    buffer_load_dwordx4 v[84:87], v212, s[60:63], s3 offen offset:0 sc0 sc1
    buffer_load_dwordx4 v[88:91], v212, s[60:63], s3 offen offset:512 sc0 sc1
    buffer_load_dwordx4 v[108:111], v212, s[60:63], s3 offen offset:1024 sc0 sc1
    buffer_load_dwordx4 v[112:115], v212, s[60:63], s3 offen offset:1536 sc0 sc1
    buffer_load_dwordx4 v[116:119], v212, s[60:63], s3 offen offset:2048 sc0 sc1
    buffer_load_dwordx4 v[120:123], v212, s[60:63], s3 offen offset:2560 sc0 sc1
    buffer_load_dwordx4 v[36:39], v212, s[60:63], s3 offen offset:3072 sc0 sc1
    buffer_load_dwordx4 v[40:43], v212, s[60:63], s3 offen offset:3584 sc0 sc1
    s_add_u32 s3, s79, 4096
    buffer_load_dwordx4 v[44:47], v212, s[60:63], s3 offen offset:0 sc0 sc1
    buffer_load_dwordx4 v[48:51], v212, s[60:63], s3 offen offset:512 sc0 sc1
    buffer_load_dwordx4 v[52:55], v212, s[60:63], s3 offen offset:1024 sc0 sc1
    buffer_load_dwordx4 v[56:59], v212, s[60:63], s3 offen offset:1536 sc0 sc1
    buffer_load_dwordx4 v[60:63], v212, s[60:63], s3 offen offset:2048 sc0 sc1
    buffer_load_dwordx4 v[64:67], v212, s[60:63], s3 offen offset:2560 sc0 sc1
    buffer_load_dwordx4 v[220:223], v212, s[60:63], s3 offen offset:3072 sc0 sc1
L_POLL1:
    v_mov_b32 v72, 0
    v_mov_b32 v73, 0
    v_mov_b32 v75, 1
    s_waitcnt vmcnt(0)
    v_fma_f32 v74, v31, v72, v84
    v_fmac_f32 v86, v31, v73
    v_and_b32 v75, v75, v85
    v_fmac_f32 v86, v32, v72
    v_fma_f32 v72, -v32, v73, v74
    v_and_b32 v75, v75, v87
    v_mov_b32 v73, v86
    s_cmp_le_u32 s64, 1
    s_cbranch_scc1 L_LEND
    v_fma_f32 v74, v31, v72, v88
    v_fmac_f32 v90, v31, v73
    v_and_b32 v75, v75, v89
    v_fmac_f32 v90, v32, v72
    v_fma_f32 v72, -v32, v73, v74
    v_and_b32 v75, v75, v91
    v_mov_b32 v73, v90
    s_cmp_le_u32 s64, 2
    s_cbranch_scc1 L_LEND
    v_fma_f32 v74, v31, v72, v108
    v_fmac_f32 v110, v31, v73
    v_and_b32 v75, v75, v109
    v_fmac_f32 v110, v32, v72
    v_fma_f32 v72, -v32, v73, v74
    v_and_b32 v75, v75, v111
    v_mov_b32 v73, v110
    s_cmp_le_u32 s64, 3
    s_cbranch_scc1 L_LEND
    v_fma_f32 v74, v31, v72, v112
    v_fmac_f32 v114, v31, v73
    v_and_b32 v75, v75, v113
    v_fmac_f32 v114, v32, v72
    v_fma_f32 v72, -v32, v73, v74
    v_and_b32 v75, v75, v115
    v_mov_b32 v73, v114
    s_cmp_le_u32 s64, 4
    s_cbranch_scc1 L_LEND
    v_fma_f32 v74, v31, v72, v116
    v_fmac_f32 v118, v31, v73
    v_and_b32 v75, v75, v117
    v_fmac_f32 v118, v32, v72
    v_fma_f32 v72, -v32, v73, v74
    v_and_b32 v75, v75, v119
    v_mov_b32 v73, v118
    s_cmp_le_u32 s64, 5
    s_cbranch_scc1 L_LEND
    v_fma_f32 v74, v31, v72, v120
    v_fmac_f32 v122, v31, v73
    v_and_b32 v75, v75, v121
    v_fmac_f32 v122, v32, v72
    v_fma_f32 v72, -v32, v73, v74
    v_and_b32 v75, v75, v123
    v_mov_b32 v73, v122
    s_cmp_le_u32 s64, 6
    s_cbranch_scc1 L_LEND
    v_fma_f32 v74, v31, v72, v36
    v_fmac_f32 v38, v31, v73
    v_and_b32 v75, v75, v37
    v_fmac_f32 v38, v32, v72
    v_fma_f32 v72, -v32, v73, v74
    v_and_b32 v75, v75, v39
    v_mov_b32 v73, v38
    s_cmp_le_u32 s64, 7
    s_cbranch_scc1 L_LEND
    v_fma_f32 v74, v31, v72, v40
    v_fmac_f32 v42, v31, v73
    v_and_b32 v75, v75, v41
    v_fmac_f32 v42, v32, v72
    v_fma_f32 v72, -v32, v73, v74
    v_and_b32 v75, v75, v43
    v_mov_b32 v73, v42
    s_cmp_le_u32 s64, 8
    s_cbranch_scc1 L_LEND
    v_fma_f32 v74, v31, v72, v44
    v_fmac_f32 v46, v31, v73
    v_and_b32 v75, v75, v45
    v_fmac_f32 v46, v32, v72
    v_fma_f32 v72, -v32, v73, v74
    v_and_b32 v75, v75, v47
    v_mov_b32 v73, v46
    s_cmp_le_u32 s64, 9
    s_cbranch_scc1 L_LEND
    v_fma_f32 v74, v31, v72, v48
    v_fmac_f32 v50, v31, v73
    v_and_b32 v75, v75, v49
    v_fmac_f32 v50, v32, v72
    v_fma_f32 v72, -v32, v73, v74
    v_and_b32 v75, v75, v51
    v_mov_b32 v73, v50
    s_cmp_le_u32 s64, 10
    s_cbranch_scc1 L_LEND
    v_fma_f32 v74, v31, v72, v52
    v_fmac_f32 v54, v31, v73
    v_and_b32 v75, v75, v53
    v_fmac_f32 v54, v32, v72
    v_fma_f32 v72, -v32, v73, v74
    v_and_b32 v75, v75, v55
    v_mov_b32 v73, v54
    s_cmp_le_u32 s64, 11
    s_cbranch_scc1 L_LEND
    v_fma_f32 v74, v31, v72, v56
    v_fmac_f32 v58, v31, v73
    v_and_b32 v75, v75, v57
    v_fmac_f32 v58, v32, v72
    v_fma_f32 v72, -v32, v73, v74
    v_and_b32 v75, v75, v59
    v_mov_b32 v73, v58
    s_cmp_le_u32 s64, 12
    s_cbranch_scc1 L_LEND
    v_fma_f32 v74, v31, v72, v60
    v_fmac_f32 v62, v31, v73
    v_and_b32 v75, v75, v61
    v_fmac_f32 v62, v32, v72
    v_fma_f32 v72, -v32, v73, v74
    v_and_b32 v75, v75, v63
    v_mov_b32 v73, v62
    s_cmp_le_u32 s64, 13
    s_cbranch_scc1 L_LEND
    v_fma_f32 v74, v31, v72, v64
    v_fmac_f32 v66, v31, v73
    v_and_b32 v75, v75, v65
    v_fmac_f32 v66, v32, v72
    v_fma_f32 v72, -v32, v73, v74
    v_and_b32 v75, v75, v67
    v_mov_b32 v73, v66
    s_cmp_le_u32 s64, 14
    s_cbranch_scc1 L_LEND
    v_fma_f32 v74, v31, v72, v220
    v_fmac_f32 v222, v31, v73
    v_and_b32 v75, v75, v221
    v_fmac_f32 v222, v32, v72
    v_fma_f32 v72, -v32, v73, v74
    v_and_b32 v75, v75, v223
    v_mov_b32 v73, v222
L_LEND:
    v_cmp_ne_u32 vcc, 1, v75
    s_nop 1
    s_cmp_eq_u64 vcc, 0
    s_cbranch_scc1 L_GDONE
    s_add_u32 s93, s93, 1
    s_cmp_lt_u32 s93, 0x40000
    s_cbranch_scc1 L_POLL
L_GDONE:
    s_nop 1
    ds_write_b64 v211, v[72:73] offset:4096
    s_waitcnt lgkmcnt(0)
L_NOPOLL:
    s_waitcnt vmcnt(0)
    s_barrier
    s_lshl_b32 s3, s64, 8
    s_lshl_b32 s4, s65, 2
    s_add_u32 s3, s3, s4
    s_add_u32 s78, s3, 14794752
    s_cmp_lg_u32 s66, 6
    s_cbranch_scc1 L_NOFA
    v_mov_b32 v74, 1
    v_mov_b32 v75, 0
    s_mov_b64 exec, 1
    buffer_store_dword v74, v75, s[60:63], s78 offen sc0 sc1
    s_mov_b64 exec, -1
L_NOFA:
    ds_read_b64 v[72:73], v210 offset:4096
    s_lshl_b32 s3, s64, 2
    s_add_u32 s3, s3, s71
    s_mul_i32 s3, s3, 56
    s_lshl_b32 s4, s65, 1
    s_add_u32 s4, s4, s69
    s_add_u32 s3, s3, s4
    s_lshl_b32 s3, s3, 10
    s_add_u32 s3, s3, 10485760
    s_add_u32 s4, s3, 28672
    s_waitcnt lgkmcnt(0)
    v_fmac_f32 v68, v27, v72
    v_fmac_f32 v69, v27, v73
    v_fma_f32 v68, -v28, v73, v68
    v_fmac_f32 v69, v28, v72
    v_fmac_f32 v140, v21, v68
    v_fmac_f32 v196, v21, v69
    v_fma_f32 v140, -v22, v69, v140
    v_fmac_f32 v196, v22, v68
    v_fmac_f32 v141, v21, v140
    v_fmac_f32 v197, v21, v196
    v_fma_f32 v141, -v22, v196, v141
    v_fmac_f32 v197, v22, v140
    v_fmac_f32 v142, v21, v141
    v_fmac_f32 v198, v21, v197
    v_cvt_pk_bf16_f32 v156, v140, v141
    v_cvt_pk_bf16_f32 v160, -v196, -v197
    v_fma_f32 v142, -v22, v197, v142
    v_fmac_f32 v198, v22, v141
    v_fmac_f32 v143, v21, v142
    v_fmac_f32 v199, v21, v198
    v_fma_f32 v143, -v22, v198, v143
    v_fmac_f32 v199, v22, v142
    v_fmac_f32 v144, v21, v143
    v_fmac_f32 v200, v21, v199
    v_cvt_pk_bf16_f32 v157, v142, v143
    v_cvt_pk_bf16_f32 v161, -v198, -v199
    v_fma_f32 v144, -v22, v199, v144
    v_fmac_f32 v200, v22, v143
    v_fmac_f32 v145, v21, v144
    v_fmac_f32 v201, v21, v200
    v_fma_f32 v145, -v22, v200, v145
    v_fmac_f32 v201, v22, v144
    v_fmac_f32 v146, v21, v145
    v_fmac_f32 v202, v21, v201
    v_cvt_pk_bf16_f32 v158, v144, v145
    v_cvt_pk_bf16_f32 v162, -v200, -v201
    v_fma_f32 v146, -v22, v201, v146
    v_fmac_f32 v202, v22, v145
    v_fmac_f32 v147, v21, v146
    v_fmac_f32 v203, v21, v202
    v_fma_f32 v147, -v22, v202, v147
    v_fmac_f32 v203, v22, v146
    v_cvt_pk_bf16_f32 v159, v146, v147
    v_cvt_pk_bf16_f32 v163, -v202, -v203
    ds_write_b64 v216, v[156:157] offset:0
    ds_write_b64 v216, v[158:159] offset:16
    ds_write_b64 v216, v[160:161] offset:1152
    ds_write_b64 v216, v[162:163] offset:1168
    s_waitcnt lgkmcnt(0)
    ds_read_b64_tr_b16 v[164:165], v217 offset:0
    ds_read_b64_tr_b16 v[166:167], v217 offset:288
    ds_read_b64_tr_b16 v[168:169], v217 offset:1152
    ds_read_b64_tr_b16 v[170:171], v217 offset:1440
    s_waitcnt lgkmcnt(0)
    buffer_store_dwordx4 v[164:167], v214, s[60:63], s3 offen sc0 sc1
    buffer_store_dwordx4 v[168:171], v214, s[60:63], s4 offen sc0 sc1
    s_waitcnt vmcnt(0)
    s_barrier
    s_cmp_lg_u32 s66, 7
    s_cbranch_scc1 L_NOFLAG
    v_mov_b32 v32, 1
    v_mov_b32 v33, 0
    s_mov_b64 exec, 1
    buffer_store_dword v32, v33, s[60:63], s78 offen offset:64 sc0 sc1
    s_mov_b64 exec, -1
L_NOFLAG:
    s_cmp_ge_u32 s66, 5
    s_cbranch_scc1 L_SROLE
    ds_read_b64_tr_b16 v[152:153], v250 offset:0
    ds_read_b64_tr_b16 v[154:155], v250 offset:1024
    ds_read_b64_tr_b16 v[156:157], v251 offset:0
    ds_read_b64_tr_b16 v[158:159], v251 offset:1024
    ds_read_b64_tr_b16 v[160:161], v250 offset:2048
    ds_read_b64_tr_b16 v[162:163], v250 offset:3072
    ds_read_b64_tr_b16 v[164:165], v251 offset:2048
    ds_read_b64_tr_b16 v[166:167], v251 offset:3072
    ds_read_b64_tr_b16 v[168:169], v250 offset:4096
    ds_read_b64_tr_b16 v[170:171], v250 offset:5120
    ds_read_b64_tr_b16 v[172:173], v251 offset:4096
    ds_read_b64_tr_b16 v[174:175], v251 offset:5120
    ds_read_b64_tr_b16 v[176:177], v250 offset:6144
    ds_read_b64_tr_b16 v[178:179], v250 offset:7168
    ds_read_b64_tr_b16 v[180:181], v251 offset:6144
    ds_read_b64_tr_b16 v[182:183], v251 offset:7168
    ds_read_b64_tr_b16 v[184:185], v250 offset:8192
    ds_read_b64_tr_b16 v[186:187], v250 offset:9216
    ds_read_b64_tr_b16 v[188:189], v251 offset:8192
    ds_read_b64_tr_b16 v[190:191], v251 offset:9216
    ds_read_b64_tr_b16 v[192:193], v250 offset:10240
    ds_read_b64_tr_b16 v[194:195], v250 offset:11264
    ds_read_b64_tr_b16 v[196:197], v251 offset:10240
    ds_read_b64_tr_b16 v[198:199], v251 offset:11264
    ds_read_b64_tr_b16 v[200:201], v250 offset:12288
    ds_read_b64_tr_b16 v[202:203], v250 offset:13312
    ds_read_b64_tr_b16 v[204:205], v251 offset:12288
    ds_read_b64_tr_b16 v[206:207], v251 offset:13312
    ds_read_b64_tr_b16 v[208:209], v250 offset:14336
    ds_read_b64_tr_b16 v[210:211], v250 offset:15360
    ds_read_b64_tr_b16 v[212:213], v251 offset:14336
    ds_read_b64_tr_b16 v[214:215], v251 offset:15360
    s_waitcnt lgkmcnt(0)
    s_add_u32 m0, s90, 0
    s_add_u32 s77, s91, 114688
    s_add_u32 s76, s91, 120832
    buffer_load_dwordx4 v248, s[52:55], s77 offen lds
    buffer_load_dwordx4 v248, s[52:55], s76 offen offset:1024 lds
    s_add_u32 m0, s90, 2048
    s_add_u32 s77, s91, 129024
    s_add_u32 s76, s91, 135168
    buffer_load_dwordx4 v248, s[52:55], s77 offen lds
    buffer_load_dwordx4 v248, s[52:55], s76 offen offset:1024 lds
    s_add_u32 m0, s90, 4096
    s_add_u32 s77, s91, 143360
    s_add_u32 s76, s91, 149504
    buffer_load_dwordx4 v248, s[52:55], s77 offen lds
    buffer_load_dwordx4 v248, s[52:55], s76 offen offset:1024 lds
    s_add_u32 m0, s90, 6144
    s_add_u32 s77, s91, 157696
    s_add_u32 s76, s91, 163840
    buffer_load_dwordx4 v248, s[52:55], s77 offen lds
    buffer_load_dwordx4 v248, s[52:55], s76 offen offset:1024 lds
    s_add_u32 m0, s90, 8192
    s_add_u32 s77, s91, 172032
    s_add_u32 s76, s91, 178176
    buffer_load_dwordx4 v248, s[52:55], s77 offen lds
    buffer_load_dwordx4 v248, s[52:55], s76 offen offset:1024 lds
    s_add_u32 m0, s90, 10240
    s_add_u32 s77, s91, 186368
    s_add_u32 s76, s91, 192512
    buffer_load_dwordx4 v248, s[52:55], s77 offen lds
    buffer_load_dwordx4 v248, s[52:55], s76 offen offset:1024 lds
    s_add_u32 m0, s90, 12288
    s_add_u32 s77, s91, 200704
    s_add_u32 s76, s91, 206848
    buffer_load_dwordx4 v248, s[52:55], s77 offen lds
    buffer_load_dwordx4 v248, s[52:55], s76 offen offset:1024 lds
    s_add_u32 m0, s90, 14336
    s_add_u32 s77, s91, 215040
    s_add_u32 s76, s91, 221184
    buffer_load_dwordx4 v248, s[52:55], s77 offen lds
    buffer_load_dwordx4 v248, s[52:55], s76 offen offset:1024 lds
    s_mov_b32 s68, s42
    s_and_b32 s69, s43, 0xffff
    s_mov_b32 s70, 3670016
    s_mov_b32 s71, 0x20000
    v_lshlrev_b32 v8, 4, v1
    v_and_b32 v24, 15, v1
    s_lshl_b32 s3, s89, 6
    v_lshl_add_u32 v24, v24, 2, s3
    v_lshlrev_b32 v25, 1, v24
    global_load_dwordx2 v[30:31], v25, s[32:33]
    v_lshrrev_b32 v26, 4, v1
    v_lshlrev_b32 v26, 4, v26
    s_lshl_b32 s3, s66, 1
    s_add_u32 s3, s3, 0
    v_add_u32 v26, s3, v26
    v_and_b32 v27, 31, v26
    v_and_b32 v28, 3, v27
    v_bfe_u32 v29, v27, 3, 2
    v_lshl_or_b32 v28, v29, 2, v28
    v_bfe_u32 v29, v27, 2, 1
    v_lshl_or_b32 v28, v29, 4, v28
    v_and_b32 v29, 32, v26
    v_or_b32 v28, v28, v29
    s_lshl_b32 s3, s88, 6
    v_add_u32 v28, s3, v28
    v_mul_u32_u24 v28, 896, v28
    v_add_u32 v28, v28, v25
    buffer_load_dwordx2 v[10:11], v28, s[8:11], 0 offen
    v_lshlrev_b32 v22, 1, v28
    v_add_u32 v26, s3, v26
    v_lshlrev_b32 v26, 2, v26
    s_mov_b32 s4, 14942208
    s_mov_b32 s5, 14950400
    s_mov_b32 s6, 14958592
    buffer_load_dword v12, v26, s[60:63], s4 offen sc1
    buffer_load_dword v13, v26, s[60:63], s5 offen sc1
    buffer_load_dword v14, v26, s[60:63], s6 offen sc1
    v_lshrrev_b32 v26, 4, v1
    v_lshlrev_b32 v26, 4, v26
    s_lshl_b32 s3, s66, 1
    s_add_u32 s3, s3, 1
    v_add_u32 v26, s3, v26
    v_and_b32 v27, 31, v26
    v_and_b32 v28, 3, v27
    v_bfe_u32 v29, v27, 3, 2
    v_lshl_or_b32 v28, v29, 2, v28
    v_bfe_u32 v29, v27, 2, 1
    v_lshl_or_b32 v28, v29, 4, v28
    v_and_b32 v29, 32, v26
    v_or_b32 v28, v28, v29
    s_lshl_b32 s3, s88, 6
    v_add_u32 v28, s3, v28
    v_mul_u32_u24 v28, 896, v28
    v_add_u32 v28, v28, v25
    buffer_load_dwordx2 v[16:17], v28, s[8:11], 0 offen
    v_lshlrev_b32 v23, 1, v28
    v_add_u32 v26, s3, v26
    v_lshlrev_b32 v26, 2, v26
    s_mov_b32 s4, 14942208
    s_mov_b32 s5, 14950400
    s_mov_b32 s6, 14958592
    buffer_load_dword v18, v26, s[60:63], s4 offen sc1
    buffer_load_dword v19, v26, s[60:63], s5 offen sc1
    buffer_load_dword v20, v26, s[60:63], s6 offen sc1
    s_waitcnt vmcnt(23)
    ds_read_b64_tr_b16 v[216:217], v250 offset:0
    ds_read_b64_tr_b16 v[218:219], v250 offset:1024
    ds_read_b64_tr_b16 v[220:221], v251 offset:0
    ds_read_b64_tr_b16 v[222:223], v251 offset:1024
    s_waitcnt vmcnt(21)
    ds_read_b64_tr_b16 v[224:225], v250 offset:2048
    ds_read_b64_tr_b16 v[226:227], v250 offset:3072
    ds_read_b64_tr_b16 v[228:229], v251 offset:2048
    ds_read_b64_tr_b16 v[230:231], v251 offset:3072
    s_waitcnt vmcnt(19)
    ds_read_b64_tr_b16 v[232:233], v250 offset:4096
    ds_read_b64_tr_b16 v[234:235], v250 offset:5120
    ds_read_b64_tr_b16 v[236:237], v251 offset:4096
    ds_read_b64_tr_b16 v[238:239], v251 offset:5120
    s_waitcnt vmcnt(17)
    ds_read_b64_tr_b16 v[240:241], v250 offset:6144
    ds_read_b64_tr_b16 v[242:243], v250 offset:7168
    ds_read_b64_tr_b16 v[244:245], v251 offset:6144
    ds_read_b64_tr_b16 v[246:247], v251 offset:7168
    s_waitcnt lgkmcnt(0)
    s_add_u32 m0, s90, 0
    s_add_u32 s77, s91, 229376
    s_add_u32 s76, s91, 235520
    buffer_load_dwordx4 v248, s[52:55], s77 offen lds
    buffer_load_dwordx4 v248, s[52:55], s76 offen offset:1024 lds
    s_add_u32 m0, s90, 2048
    s_add_u32 s77, s91, 243712
    s_add_u32 s76, s91, 249856
    buffer_load_dwordx4 v248, s[52:55], s77 offen lds
    buffer_load_dwordx4 v248, s[52:55], s76 offen offset:1024 lds
    s_add_u32 m0, s90, 4096
    s_add_u32 s77, s91, 258048
    s_add_u32 s76, s91, 264192
    buffer_load_dwordx4 v248, s[52:55], s77 offen lds
    buffer_load_dwordx4 v248, s[52:55], s76 offen offset:1024 lds
    s_add_u32 m0, s90, 6144
    s_add_u32 s77, s91, 272384
    s_add_u32 s76, s91, 278528
    buffer_load_dwordx4 v248, s[52:55], s77 offen lds
    buffer_load_dwordx4 v248, s[52:55], s76 offen offset:1024 lds
    s_lshl_b32 s3, s88, 1
    s_mul_i32 s3, s3, 112
    s_add_u32 s3, s3, s94
    s_lshl_b32 s3, s3, 10
    s_add_u32 s73, s3, 2097152
    v_mov_b32 v6, 162816
L_SPINF:
    ds_read_b32 v7, v6
    s_waitcnt lgkmcnt(0)
    v_readfirstlane_b32 s3, v7
    s_nop 0
    s_cmp_lg_u32 s3, 0
    s_cbranch_scc1 L_GOF
    s_sleep 1
    s_branch L_SPINF
L_GOF:
    s_add_u32 s75, s73, 0
    s_add_u32 s74, s75, 114688
    buffer_load_dwordx4 v[112:115], v8, s[60:63], s75 offen offset:0 sc1
    buffer_load_dwordx4 v[116:119], v8, s[60:63], s74 offen offset:0 sc1
    buffer_load_dwordx4 v[120:123], v8, s[60:63], s75 offen offset:1024 sc1
    buffer_load_dwordx4 v[124:127], v8, s[60:63], s74 offen offset:1024 sc1
    buffer_load_dwordx4 v[128:131], v8, s[60:63], s75 offen offset:2048 sc1
    buffer_load_dwordx4 v[132:135], v8, s[60:63], s74 offen offset:2048 sc1
    buffer_load_dwordx4 v[136:139], v8, s[60:63], s75 offen offset:3072 sc1
    buffer_load_dwordx4 v[140:143], v8, s[60:63], s74 offen offset:3072 sc1
    s_add_u32 s75, s73, 4096
    s_add_u32 s74, s75, 114688
    buffer_load_dwordx4 v[144:147], v8, s[60:63], s75 offen offset:0 sc1
    buffer_load_dwordx4 v[148:151], v8, s[60:63], s74 offen offset:0 sc1
    s_waitcnt vmcnt(8)
    v_mfma_f32_32x32x16_bf16 v[48:63], v[152:155], v[112:115], 0
    v_mfma_f32_32x32x16_bf16 v[64:79], v[152:155], v[116:119], 0
    v_mfma_f32_32x32x16_bf16 v[80:95], v[156:159], v[112:115], 0
    v_mfma_f32_32x32x16_bf16 v[96:111], v[156:159], v[116:119], 0
    buffer_load_dwordx4 v[112:115], v8, s[60:63], s75 offen offset:1024 sc1
    buffer_load_dwordx4 v[116:119], v8, s[60:63], s74 offen offset:1024 sc1
    s_waitcnt vmcnt(8)
    v_mfma_f32_32x32x16_bf16 v[48:63], v[160:163], v[120:123], v[48:63]
    v_mfma_f32_32x32x16_bf16 v[64:79], v[160:163], v[124:127], v[64:79]
    v_mfma_f32_32x32x16_bf16 v[80:95], v[164:167], v[120:123], v[80:95]
    v_mfma_f32_32x32x16_bf16 v[96:111], v[164:167], v[124:127], v[96:111]
    buffer_load_dwordx4 v[120:123], v8, s[60:63], s75 offen offset:2048 sc1
    buffer_load_dwordx4 v[124:127], v8, s[60:63], s74 offen offset:2048 sc1
    s_waitcnt vmcnt(8)
    v_mfma_f32_32x32x16_bf16 v[48:63], v[168:171], v[128:131], v[48:63]
    v_mfma_f32_32x32x16_bf16 v[64:79], v[168:171], v[132:135], v[64:79]
    v_mfma_f32_32x32x16_bf16 v[80:95], v[172:175], v[128:131], v[80:95]
    v_mfma_f32_32x32x16_bf16 v[96:111], v[172:175], v[132:135], v[96:111]
    buffer_load_dwordx4 v[128:131], v8, s[60:63], s75 offen offset:3072 sc1
    buffer_load_dwordx4 v[132:135], v8, s[60:63], s74 offen offset:3072 sc1
    s_waitcnt vmcnt(8)
    v_mfma_f32_32x32x16_bf16 v[48:63], v[176:179], v[136:139], v[48:63]
    v_mfma_f32_32x32x16_bf16 v[64:79], v[176:179], v[140:143], v[64:79]
    v_mfma_f32_32x32x16_bf16 v[80:95], v[180:183], v[136:139], v[80:95]
    v_mfma_f32_32x32x16_bf16 v[96:111], v[180:183], v[140:143], v[96:111]
    s_add_u32 s75, s73, 8192
    s_add_u32 s74, s75, 114688
    buffer_load_dwordx4 v[136:139], v8, s[60:63], s75 offen offset:0 sc1
    buffer_load_dwordx4 v[140:143], v8, s[60:63], s74 offen offset:0 sc1
    s_waitcnt vmcnt(8)
    v_mfma_f32_32x32x16_bf16 v[48:63], v[184:187], v[144:147], v[48:63]
    v_mfma_f32_32x32x16_bf16 v[64:79], v[184:187], v[148:151], v[64:79]
    v_mfma_f32_32x32x16_bf16 v[80:95], v[188:191], v[144:147], v[80:95]
    v_mfma_f32_32x32x16_bf16 v[96:111], v[188:191], v[148:151], v[96:111]
    buffer_load_dwordx4 v[144:147], v8, s[60:63], s75 offen offset:1024 sc1
    buffer_load_dwordx4 v[148:151], v8, s[60:63], s74 offen offset:1024 sc1
    s_waitcnt vmcnt(8)
    v_mfma_f32_32x32x16_bf16 v[48:63], v[192:195], v[112:115], v[48:63]
    v_mfma_f32_32x32x16_bf16 v[64:79], v[192:195], v[116:119], v[64:79]
    v_mfma_f32_32x32x16_bf16 v[80:95], v[196:199], v[112:115], v[80:95]
    v_mfma_f32_32x32x16_bf16 v[96:111], v[196:199], v[116:119], v[96:111]
    buffer_load_dwordx4 v[112:115], v8, s[60:63], s75 offen offset:2048 sc1
    buffer_load_dwordx4 v[116:119], v8, s[60:63], s74 offen offset:2048 sc1
    s_waitcnt vmcnt(8)
    v_mfma_f32_32x32x16_bf16 v[48:63], v[200:203], v[120:123], v[48:63]
    v_mfma_f32_32x32x16_bf16 v[64:79], v[200:203], v[124:127], v[64:79]
    v_mfma_f32_32x32x16_bf16 v[80:95], v[204:207], v[120:123], v[80:95]
    v_mfma_f32_32x32x16_bf16 v[96:111], v[204:207], v[124:127], v[96:111]
    buffer_load_dwordx4 v[120:123], v8, s[60:63], s75 offen offset:3072 sc1
    buffer_load_dwordx4 v[124:127], v8, s[60:63], s74 offen offset:3072 sc1
    s_waitcnt vmcnt(8)
    v_mfma_f32_32x32x16_bf16 v[48:63], v[208:211], v[128:131], v[48:63]
    v_mfma_f32_32x32x16_bf16 v[64:79], v[208:211], v[132:135], v[64:79]
    v_mfma_f32_32x32x16_bf16 v[80:95], v[212:215], v[128:131], v[80:95]
    v_mfma_f32_32x32x16_bf16 v[96:111], v[212:215], v[132:135], v[96:111]
    s_add_u32 s75, s73, 12288
    s_add_u32 s74, s75, 114688
    buffer_load_dwordx4 v[128:131], v8, s[60:63], s75 offen offset:0 sc1
    buffer_load_dwordx4 v[132:135], v8, s[60:63], s74 offen offset:0 sc1
    s_waitcnt vmcnt(8)
    v_mfma_f32_32x32x16_bf16 v[48:63], v[216:219], v[136:139], v[48:63]
    v_mfma_f32_32x32x16_bf16 v[64:79], v[216:219], v[140:143], v[64:79]
    v_mfma_f32_32x32x16_bf16 v[80:95], v[220:223], v[136:139], v[80:95]
    v_mfma_f32_32x32x16_bf16 v[96:111], v[220:223], v[140:143], v[96:111]
    buffer_load_dwordx4 v[136:139], v8, s[60:63], s75 offen offset:1024 sc1
    buffer_load_dwordx4 v[140:143], v8, s[60:63], s74 offen offset:1024 sc1
    s_waitcnt vmcnt(8)
    v_mfma_f32_32x32x16_bf16 v[48:63], v[224:227], v[144:147], v[48:63]
    v_mfma_f32_32x32x16_bf16 v[64:79], v[224:227], v[148:151], v[64:79]
    v_mfma_f32_32x32x16_bf16 v[80:95], v[228:231], v[144:147], v[80:95]
    v_mfma_f32_32x32x16_bf16 v[96:111], v[228:231], v[148:151], v[96:111]
    buffer_load_dwordx4 v[144:147], v8, s[60:63], s75 offen offset:2048 sc1
    buffer_load_dwordx4 v[148:151], v8, s[60:63], s74 offen offset:2048 sc1
    s_waitcnt vmcnt(8)
    v_mfma_f32_32x32x16_bf16 v[48:63], v[232:235], v[112:115], v[48:63]
    v_mfma_f32_32x32x16_bf16 v[64:79], v[232:235], v[116:119], v[64:79]
    v_mfma_f32_32x32x16_bf16 v[80:95], v[236:239], v[112:115], v[80:95]
    v_mfma_f32_32x32x16_bf16 v[96:111], v[236:239], v[116:119], v[96:111]
    buffer_load_dwordx4 v[112:115], v8, s[60:63], s75 offen offset:3072 sc1
    buffer_load_dwordx4 v[116:119], v8, s[60:63], s74 offen offset:3072 sc1
    ds_read_b64_tr_b16 v[32:33], v250 offset:8192
    ds_read_b64_tr_b16 v[34:35], v250 offset:9216
    ds_read_b64_tr_b16 v[36:37], v251 offset:8192
    ds_read_b64_tr_b16 v[38:39], v251 offset:9216
    s_waitcnt vmcnt(8)
    v_mfma_f32_32x32x16_bf16 v[48:63], v[240:243], v[120:123], v[48:63]
    v_mfma_f32_32x32x16_bf16 v[64:79], v[240:243], v[124:127], v[64:79]
    v_mfma_f32_32x32x16_bf16 v[80:95], v[244:247], v[120:123], v[80:95]
    v_mfma_f32_32x32x16_bf16 v[96:111], v[244:247], v[124:127], v[96:111]
    s_add_u32 s75, s73, 16384
    s_add_u32 s74, s75, 114688
    buffer_load_dwordx4 v[120:123], v8, s[60:63], s75 offen offset:0 sc1
    buffer_load_dwordx4 v[124:127], v8, s[60:63], s74 offen offset:0 sc1
    ds_read_b64_tr_b16 v[40:41], v250 offset:10240
    ds_read_b64_tr_b16 v[42:43], v250 offset:11264
    ds_read_b64_tr_b16 v[44:45], v251 offset:10240
    ds_read_b64_tr_b16 v[46:47], v251 offset:11264
    s_waitcnt vmcnt(8)
    s_waitcnt lgkmcnt(4)
    v_mfma_f32_32x32x16_bf16 v[48:63], v[32:35], v[128:131], v[48:63]
    v_mfma_f32_32x32x16_bf16 v[64:79], v[32:35], v[132:135], v[64:79]
    v_mfma_f32_32x32x16_bf16 v[80:95], v[36:39], v[128:131], v[80:95]
    v_mfma_f32_32x32x16_bf16 v[96:111], v[36:39], v[132:135], v[96:111]
    buffer_load_dwordx4 v[128:131], v8, s[60:63], s75 offen offset:1024 sc1
    buffer_load_dwordx4 v[132:135], v8, s[60:63], s74 offen offset:1024 sc1
    s_add_u32 m0, s90, 8192
    s_add_u32 s77, s91, 286720
    s_add_u32 s76, s91, 292864
    buffer_load_dwordx4 v248, s[52:55], s77 offen lds
    buffer_load_dwordx4 v248, s[52:55], s76 offen offset:1024 lds
    ds_read_b64_tr_b16 v[32:33], v250 offset:12288
    ds_read_b64_tr_b16 v[34:35], v250 offset:13312
    ds_read_b64_tr_b16 v[36:37], v251 offset:12288
    ds_read_b64_tr_b16 v[38:39], v251 offset:13312
    s_waitcnt vmcnt(10)
    s_waitcnt lgkmcnt(4)
    v_mfma_f32_32x32x16_bf16 v[48:63], v[40:43], v[136:139], v[48:63]
    v_mfma_f32_32x32x16_bf16 v[64:79], v[40:43], v[140:143], v[64:79]
    v_mfma_f32_32x32x16_bf16 v[80:95], v[44:47], v[136:139], v[80:95]
    v_mfma_f32_32x32x16_bf16 v[96:111], v[44:47], v[140:143], v[96:111]
    buffer_load_dwordx4 v[136:139], v8, s[60:63], s75 offen offset:2048 sc1
    buffer_load_dwordx4 v[140:143], v8, s[60:63], s74 offen offset:2048 sc1
    s_add_u32 m0, s90, 10240
    s_add_u32 s77, s91, 301056
    s_add_u32 s76, s91, 307200
    buffer_load_dwordx4 v248, s[52:55], s77 offen lds
    buffer_load_dwordx4 v248, s[52:55], s76 offen offset:1024 lds
    ds_read_b64_tr_b16 v[40:41], v250 offset:14336
    ds_read_b64_tr_b16 v[42:43], v250 offset:15360
    ds_read_b64_tr_b16 v[44:45], v251 offset:14336
    ds_read_b64_tr_b16 v[46:47], v251 offset:15360
    s_waitcnt vmcnt(12)
    s_waitcnt lgkmcnt(4)
    v_mfma_f32_32x32x16_bf16 v[48:63], v[32:35], v[144:147], v[48:63]
    v_mfma_f32_32x32x16_bf16 v[64:79], v[32:35], v[148:151], v[64:79]
    v_mfma_f32_32x32x16_bf16 v[80:95], v[36:39], v[144:147], v[80:95]
    v_mfma_f32_32x32x16_bf16 v[96:111], v[36:39], v[148:151], v[96:111]
    buffer_load_dwordx4 v[144:147], v8, s[60:63], s75 offen offset:3072 sc1
    buffer_load_dwordx4 v[148:151], v8, s[60:63], s74 offen offset:3072 sc1
    s_add_u32 m0, s90, 12288
    s_add_u32 s77, s91, 315392
    s_add_u32 s76, s91, 321536
    buffer_load_dwordx4 v248, s[52:55], s77 offen lds
    buffer_load_dwordx4 v248, s[52:55], s76 offen offset:1024 lds
    ds_read_b64_tr_b16 v[32:33], v250 offset:0
    ds_read_b64_tr_b16 v[34:35], v250 offset:1024
    ds_read_b64_tr_b16 v[36:37], v251 offset:0
    ds_read_b64_tr_b16 v[38:39], v251 offset:1024
    s_waitcnt vmcnt(14)
    s_waitcnt lgkmcnt(4)
    v_mfma_f32_32x32x16_bf16 v[48:63], v[40:43], v[112:115], v[48:63]
    v_mfma_f32_32x32x16_bf16 v[64:79], v[40:43], v[116:119], v[64:79]
    v_mfma_f32_32x32x16_bf16 v[80:95], v[44:47], v[112:115], v[80:95]
    v_mfma_f32_32x32x16_bf16 v[96:111], v[44:47], v[116:119], v[96:111]
    s_add_u32 s75, s73, 20480
    s_add_u32 s74, s75, 114688
    buffer_load_dwordx4 v[112:115], v8, s[60:63], s75 offen offset:0 sc1
    buffer_load_dwordx4 v[116:119], v8, s[60:63], s74 offen offset:0 sc1
    ds_read_b64_tr_b16 v[40:41], v250 offset:2048
    ds_read_b64_tr_b16 v[42:43], v250 offset:3072
    ds_read_b64_tr_b16 v[44:45], v251 offset:2048
    ds_read_b64_tr_b16 v[46:47], v251 offset:3072
    s_waitcnt vmcnt(14)
    s_waitcnt lgkmcnt(4)
    v_mfma_f32_32x32x16_bf16 v[48:63], v[32:35], v[120:123], v[48:63]
    v_mfma_f32_32x32x16_bf16 v[64:79], v[32:35], v[124:127], v[64:79]
    v_mfma_f32_32x32x16_bf16 v[80:95], v[36:39], v[120:123], v[80:95]
    v_mfma_f32_32x32x16_bf16 v[96:111], v[36:39], v[124:127], v[96:111]
    buffer_load_dwordx4 v[120:123], v8, s[60:63], s75 offen offset:1024 sc1
    buffer_load_dwordx4 v[124:127], v8, s[60:63], s74 offen offset:1024 sc1
    ds_read_b64_tr_b16 v[32:33], v250 offset:4096
    ds_read_b64_tr_b16 v[34:35], v250 offset:5120
    ds_read_b64_tr_b16 v[36:37], v251 offset:4096
    ds_read_b64_tr_b16 v[38:39], v251 offset:5120
    s_waitcnt vmcnt(14)
    s_waitcnt lgkmcnt(4)
    v_mfma_f32_32x32x16_bf16 v[48:63], v[40:43], v[128:131], v[48:63]
    v_mfma_f32_32x32x16_bf16 v[64:79], v[40:43], v[132:135], v[64:79]
    v_mfma_f32_32x32x16_bf16 v[80:95], v[44:47], v[128:131], v[80:95]
    v_mfma_f32_32x32x16_bf16 v[96:111], v[44:47], v[132:135], v[96:111]
    buffer_load_dwordx4 v[128:131], v8, s[60:63], s75 offen offset:2048 sc1
    buffer_load_dwordx4 v[132:135], v8, s[60:63], s74 offen offset:2048 sc1
    ds_read_b64_tr_b16 v[40:41], v250 offset:6144
    ds_read_b64_tr_b16 v[42:43], v250 offset:7168
    ds_read_b64_tr_b16 v[44:45], v251 offset:6144
    ds_read_b64_tr_b16 v[46:47], v251 offset:7168
    s_waitcnt vmcnt(12)
    s_waitcnt lgkmcnt(4)
    v_mfma_f32_32x32x16_bf16 v[48:63], v[32:35], v[136:139], v[48:63]
    v_mfma_f32_32x32x16_bf16 v[64:79], v[32:35], v[140:143], v[64:79]
    v_mfma_f32_32x32x16_bf16 v[80:95], v[36:39], v[136:139], v[80:95]
    v_mfma_f32_32x32x16_bf16 v[96:111], v[36:39], v[140:143], v[96:111]
    ds_read_b64_tr_b16 v[32:33], v250 offset:8192
    ds_read_b64_tr_b16 v[34:35], v250 offset:9216
    ds_read_b64_tr_b16 v[36:37], v251 offset:8192
    ds_read_b64_tr_b16 v[38:39], v251 offset:9216
    s_waitcnt vmcnt(8)
    s_waitcnt lgkmcnt(4)
    v_mfma_f32_32x32x16_bf16 v[48:63], v[40:43], v[144:147], v[48:63]
    v_mfma_f32_32x32x16_bf16 v[64:79], v[40:43], v[148:151], v[64:79]
    v_mfma_f32_32x32x16_bf16 v[80:95], v[44:47], v[144:147], v[80:95]
    v_mfma_f32_32x32x16_bf16 v[96:111], v[44:47], v[148:151], v[96:111]
    ds_read_b64_tr_b16 v[40:41], v250 offset:10240
    ds_read_b64_tr_b16 v[42:43], v250 offset:11264
    ds_read_b64_tr_b16 v[44:45], v251 offset:10240
    ds_read_b64_tr_b16 v[46:47], v251 offset:11264
    s_waitcnt vmcnt(4)
    s_waitcnt lgkmcnt(4)
    v_mfma_f32_32x32x16_bf16 v[48:63], v[32:35], v[112:115], v[48:63]
    v_mfma_f32_32x32x16_bf16 v[64:79], v[32:35], v[116:119], v[64:79]
    v_mfma_f32_32x32x16_bf16 v[80:95], v[36:39], v[112:115], v[80:95]
    v_mfma_f32_32x32x16_bf16 v[96:111], v[36:39], v[116:119], v[96:111]
    ds_read_b64_tr_b16 v[32:33], v250 offset:12288
    ds_read_b64_tr_b16 v[34:35], v250 offset:13312
    ds_read_b64_tr_b16 v[36:37], v251 offset:12288
    ds_read_b64_tr_b16 v[38:39], v251 offset:13312
    s_waitcnt vmcnt(2)
    s_waitcnt lgkmcnt(4)
    v_mfma_f32_32x32x16_bf16 v[48:63], v[40:43], v[120:123], v[48:63]
    v_mfma_f32_32x32x16_bf16 v[64:79], v[40:43], v[124:127], v[64:79]
    v_mfma_f32_32x32x16_bf16 v[80:95], v[44:47], v[120:123], v[80:95]
    v_mfma_f32_32x32x16_bf16 v[96:111], v[44:47], v[124:127], v[96:111]
    s_cmp_ge_u32 s66, 2
    s_cbranch_scc1 L_DONEF
    s_waitcnt vmcnt(0)
    s_waitcnt lgkmcnt(0)
    v_mfma_f32_32x32x16_bf16 v[48:63], v[32:35], v[128:131], v[48:63]
    v_mfma_f32_32x32x16_bf16 v[64:79], v[32:35], v[132:135], v[64:79]
    v_mfma_f32_32x32x16_bf16 v[80:95], v[36:39], v[128:131], v[80:95]
    v_mfma_f32_32x32x16_bf16 v[96:111], v[36:39], v[132:135], v[96:111]
L_DONEF:
    s_waitcnt vmcnt(0) lgkmcnt(0)
    v_and_b32 v2, 31, v1
    v_lshrrev_b32 v3, 5, v1
    v_and_b32 v4, 15, v1
    v_xor_b32 v3, v3, v4
    v_lshlrev_b32 v3, 4, v3
    v_lshl_add_u32 v2, v2, 8, v3
    v_add_u32 v2, s90, v2
    v_xor_b32 v136, 0, v2
    v_xor_b32 v137, 32, v2
    v_xor_b32 v138, 64, v2
    v_xor_b32 v139, 96, v2
    v_xor_b32 v140, 128, v2
    v_xor_b32 v141, 160, v2
    v_xor_b32 v142, 192, v2
    v_xor_b32 v143, 224, v2
    s_nop 7
    ds_write_b128 v136, v[48:51] offset:0
    ds_write_b128 v137, v[52:55] offset:0
    ds_write_b128 v138, v[56:59] offset:0
    ds_write_b128 v139, v[60:63] offset:0
    ds_write_b128 v136, v[64:67] offset:8192
    ds_write_b128 v137, v[68:71] offset:8192
    ds_write_b128 v138, v[72:75] offset:8192
    ds_write_b128 v139, v[76:79] offset:8192
    ds_write_b128 v140, v[80:83] offset:0
    ds_write_b128 v141, v[84:87] offset:0
    ds_write_b128 v142, v[88:91] offset:0
    ds_write_b128 v143, v[92:95] offset:0
    ds_write_b128 v140, v[96:99] offset:8192
    ds_write_b128 v141, v[100:103] offset:8192
    ds_write_b128 v142, v[104:107] offset:8192
    ds_write_b128 v143, v[108:111] offset:8192
    s_branch L_FIN
L_SROLE:
    s_setprio 2
    s_cmp_lg_u32 s66, 6
    s_cbranch_scc1 L_NPA
    s_lshr_b32 s3, s88, 1
    s_lshl_b32 s3, s3, 8
    s_add_u32 s3, s3, 14794752
    v_lshlrev_b32 v33, 4, v1
    s_mov_b32 s93, 0
    v_cmp_eq_u32 s[6:7], 3, v1
    v_mov_b32 v34, 162816
    s_mov_b64 exec, 15
L_FPA:
    buffer_load_dwordx4 v[36:39], v33, s[60:63], s3 offen sc0 sc1
    s_waitcnt vmcnt(0)
    v_cndmask_b32 v38, v38, 1, s[6:7]
    v_cndmask_b32 v39, v39, 1, s[6:7]
    v_and_b32 v36, v36, v37
    v_and_b32 v38, v38, v39
    v_and_b32 v36, v36, v38
    v_cmp_ne_u32 vcc, 1, v36
    s_add_u32 s93, s93, 1
    s_nop 0
    s_cmp_eq_u32 vcc_lo, 0
    s_cbranch_scc1 L_FPAOK
    s_cmp_lt_u32 s93, 0x40000
    s_cbranch_scc1 L_FPA
L_FPAOK:
    v_mov_b32 v36, 1
    ds_write_b32 v34, v36
    s_mov_b64 exec, -1
L_NPA:
    ds_read_b128 v[152:155], v250 offset:0
    ds_read_b128 v[156:159], v250 offset:4096
    ds_read_b128 v[160:163], v251 offset:0
    ds_read_b128 v[164:167], v251 offset:4096
    ds_read_b128 v[168:171], v252 offset:0
    ds_read_b128 v[172:175], v252 offset:4096
    ds_read_b128 v[176:179], v253 offset:0
    ds_read_b128 v[180:183], v253 offset:4096
    ds_read_b128 v[184:187], v250 offset:8192
    ds_read_b128 v[188:191], v250 offset:12288
    ds_read_b128 v[192:195], v251 offset:8192
    ds_read_b128 v[196:199], v251 offset:12288
    ds_read_b128 v[200:203], v252 offset:8192
    ds_read_b128 v[204:207], v252 offset:12288
    ds_read_b128 v[208:211], v253 offset:8192
    ds_read_b128 v[212:215], v253 offset:12288
    s_waitcnt lgkmcnt(0)
    s_add_u32 s76, s91, 2
    s_cmp_ge_u32 s76, 7
    s_cselect_b32 s52, s28, s26
    s_cselect_b32 s53, s29, s27
    s_cselect_b32 s77, 7, 0
    s_sub_u32 s76, s76, s77
    s_lshl_b32 s76, s76, 7
    s_and_b32 s53, s53, 0xffff
    s_add_u32 m0, s90, 0
    s_add_u32 s77, s76, 0
    buffer_load_dwordx4 v248, s[52:55], s77 offen offset:0 lds
    s_add_u32 m0, s90, 0
    s_add_u32 s77, s76, 6144
    buffer_load_dwordx4 v249, s[52:55], s77 offen offset:1024 lds
    s_add_u32 s76, s91, 2
    s_cmp_ge_u32 s76, 7
    s_cselect_b32 s52, s28, s26
    s_cselect_b32 s53, s29, s27
    s_cselect_b32 s77, 7, 0
    s_sub_u32 s76, s76, s77
    s_lshl_b32 s76, s76, 7
    s_and_b32 s53, s53, 0xffff
    s_add_u32 m0, s90, 0
    s_add_u32 s77, s76, 12288
    buffer_load_dwordx4 v248, s[52:55], s77 offen offset:2048 lds
    s_add_u32 m0, s90, 0
    s_add_u32 s77, s76, 18432
    buffer_load_dwordx4 v249, s[52:55], s77 offen offset:3072 lds
    s_add_u32 s76, s91, 2
    s_cmp_ge_u32 s76, 7
    s_cselect_b32 s52, s28, s26
    s_cselect_b32 s53, s29, s27
    s_cselect_b32 s77, 7, 0
    s_sub_u32 s76, s76, s77
    s_lshl_b32 s76, s76, 7
    s_and_b32 s53, s53, 0xffff
    s_add_u32 m0, s90, 4096
    s_add_u32 s77, s76, 28672
    buffer_load_dwordx4 v248, s[52:55], s77 offen offset:0 lds
    s_add_u32 m0, s90, 4096
    s_add_u32 s77, s76, 34816
    buffer_load_dwordx4 v249, s[52:55], s77 offen offset:1024 lds
    s_add_u32 s76, s91, 2
    s_cmp_ge_u32 s76, 7
    s_cselect_b32 s52, s28, s26
    s_cselect_b32 s53, s29, s27
    s_cselect_b32 s77, 7, 0
    s_sub_u32 s76, s76, s77
    s_lshl_b32 s76, s76, 7
    s_and_b32 s53, s53, 0xffff
    s_add_u32 m0, s90, 4096
    s_add_u32 s77, s76, 40960
    buffer_load_dwordx4 v248, s[52:55], s77 offen offset:2048 lds
    s_add_u32 m0, s90, 4096
    s_add_u32 s77, s76, 47104
    buffer_load_dwordx4 v249, s[52:55], s77 offen offset:3072 lds
    s_add_u32 s76, s91, 3
    s_cmp_ge_u32 s76, 7
    s_cselect_b32 s52, s28, s26
    s_cselect_b32 s53, s29, s27
    s_cselect_b32 s77, 7, 0
    s_sub_u32 s76, s76, s77
    s_lshl_b32 s76, s76, 7
    s_and_b32 s53, s53, 0xffff
    s_add_u32 m0, s90, 8192
    s_add_u32 s77, s76, 0
    buffer_load_dwordx4 v248, s[52:55], s77 offen offset:0 lds
    s_add_u32 m0, s90, 8192
    s_add_u32 s77, s76, 6144
    buffer_load_dwordx4 v249, s[52:55], s77 offen offset:1024 lds
    s_add_u32 s76, s91, 3
    s_cmp_ge_u32 s76, 7
    s_cselect_b32 s52, s28, s26
    s_cselect_b32 s53, s29, s27
    s_cselect_b32 s77, 7, 0
    s_sub_u32 s76, s76, s77
    s_lshl_b32 s76, s76, 7
    s_and_b32 s53, s53, 0xffff
    s_add_u32 m0, s90, 8192
    s_add_u32 s77, s76, 12288
    buffer_load_dwordx4 v248, s[52:55], s77 offen offset:2048 lds
    s_add_u32 m0, s90, 8192
    s_add_u32 s77, s76, 18432
    buffer_load_dwordx4 v249, s[52:55], s77 offen offset:3072 lds
    s_add_u32 s76, s91, 3
    s_cmp_ge_u32 s76, 7
    s_cselect_b32 s52, s28, s26
    s_cselect_b32 s53, s29, s27
    s_cselect_b32 s77, 7, 0
    s_sub_u32 s76, s76, s77
    s_lshl_b32 s76, s76, 7
    s_and_b32 s53, s53, 0xffff
    s_add_u32 m0, s90, 12288
    s_add_u32 s77, s76, 28672
    buffer_load_dwordx4 v248, s[52:55], s77 offen offset:0 lds
    s_add_u32 m0, s90, 12288
    s_add_u32 s77, s76, 34816
    buffer_load_dwordx4 v249, s[52:55], s77 offen offset:1024 lds
    s_add_u32 s76, s91, 3
    s_cmp_ge_u32 s76, 7
    s_cselect_b32 s52, s28, s26
    s_cselect_b32 s53, s29, s27
    s_cselect_b32 s77, 7, 0
    s_sub_u32 s76, s76, s77
    s_lshl_b32 s76, s76, 7
    s_and_b32 s53, s53, 0xffff
    s_add_u32 m0, s90, 12288
    s_add_u32 s77, s76, 40960
    buffer_load_dwordx4 v248, s[52:55], s77 offen offset:2048 lds
    s_add_u32 m0, s90, 12288
    s_add_u32 s77, s76, 47104
    buffer_load_dwordx4 v249, s[52:55], s77 offen offset:3072 lds
    s_mov_b32 s68, s42
    s_and_b32 s69, s43, 0xffff
    s_mov_b32 s70, 3670016
    s_mov_b32 s71, 0x20000
    v_lshlrev_b32 v8, 4, v1
    v_and_b32 v24, 15, v1
    s_lshl_b32 s3, s89, 6
    v_lshl_add_u32 v24, v24, 2, s3
    v_lshlrev_b32 v25, 1, v24
    global_load_dwordx2 v[30:31], v25, s[32:33]
    v_lshrrev_b32 v26, 4, v1
    v_lshlrev_b32 v26, 4, v26
    s_lshl_b32 s3, s66, 1
    s_add_u32 s3, s3, 0
    v_add_u32 v26, s3, v26
    v_and_b32 v27, 31, v26
    v_and_b32 v28, 3, v27
    v_bfe_u32 v29, v27, 3, 2
    v_lshl_or_b32 v28, v29, 2, v28
    v_bfe_u32 v29, v27, 2, 1
    v_lshl_or_b32 v28, v29, 4, v28
    v_and_b32 v29, 32, v26
    v_or_b32 v28, v28, v29
    s_lshl_b32 s3, s88, 6
    v_add_u32 v28, s3, v28
    v_mul_u32_u24 v28, 896, v28
    v_add_u32 v28, v28, v25
    buffer_load_dwordx2 v[10:11], v28, s[8:11], 0 offen
    v_lshlrev_b32 v22, 1, v28
    v_add_u32 v26, s3, v26
    v_lshlrev_b32 v26, 2, v26
    s_mov_b32 s4, 14942208
    s_mov_b32 s5, 14950400
    s_mov_b32 s6, 14958592
    buffer_load_dword v12, v26, s[60:63], s4 offen sc1
    buffer_load_dword v13, v26, s[60:63], s5 offen sc1
    buffer_load_dword v14, v26, s[60:63], s6 offen sc1
    v_lshrrev_b32 v26, 4, v1
    v_lshlrev_b32 v26, 4, v26
    s_lshl_b32 s3, s66, 1
    s_add_u32 s3, s3, 1
    v_add_u32 v26, s3, v26
    v_and_b32 v27, 31, v26
    v_and_b32 v28, 3, v27
    v_bfe_u32 v29, v27, 3, 2
    v_lshl_or_b32 v28, v29, 2, v28
    v_bfe_u32 v29, v27, 2, 1
    v_lshl_or_b32 v28, v29, 4, v28
    v_and_b32 v29, 32, v26
    v_or_b32 v28, v28, v29
    s_lshl_b32 s3, s88, 6
    v_add_u32 v28, s3, v28
    v_mul_u32_u24 v28, 896, v28
    v_add_u32 v28, v28, v25
    buffer_load_dwordx2 v[16:17], v28, s[8:11], 0 offen
    v_lshlrev_b32 v23, 1, v28
    v_add_u32 v26, s3, v26
    v_lshlrev_b32 v26, 2, v26
    s_mov_b32 s4, 14942208
    s_mov_b32 s5, 14950400
    s_mov_b32 s6, 14958592
    buffer_load_dword v18, v26, s[60:63], s4 offen sc1
    buffer_load_dword v19, v26, s[60:63], s5 offen sc1
    buffer_load_dword v20, v26, s[60:63], s6 offen sc1
    s_waitcnt vmcnt(17)
    ds_read_b128 v[216:219], v250 offset:0
    ds_read_b128 v[220:223], v250 offset:4096
    ds_read_b128 v[224:227], v251 offset:0
    ds_read_b128 v[228:231], v251 offset:4096
    ds_read_b128 v[232:235], v252 offset:0
    ds_read_b128 v[236:239], v252 offset:4096
    ds_read_b128 v[240:243], v253 offset:0
    ds_read_b128 v[244:247], v253 offset:4096
    s_waitcnt lgkmcnt(0)
    s_add_u32 s76, s91, 4
    s_cmp_ge_u32 s76, 7
    s_cselect_b32 s52, s28, s26
    s_cselect_b32 s53, s29, s27
    s_cselect_b32 s77, 7, 0
    s_sub_u32 s76, s76, s77
    s_lshl_b32 s76, s76, 7
    s_and_b32 s53, s53, 0xffff
    s_add_u32 m0, s90, 0
    s_add_u32 s77, s76, 0
    buffer_load_dwordx4 v248, s[52:55], s77 offen offset:0 lds
    s_add_u32 m0, s90, 0
    s_add_u32 s77, s76, 6144
    buffer_load_dwordx4 v249, s[52:55], s77 offen offset:1024 lds
    s_add_u32 s76, s91, 4
    s_cmp_ge_u32 s76, 7
    s_cselect_b32 s52, s28, s26
    s_cselect_b32 s53, s29, s27
    s_cselect_b32 s77, 7, 0
    s_sub_u32 s76, s76, s77
    s_lshl_b32 s76, s76, 7
    s_and_b32 s53, s53, 0xffff
    s_add_u32 m0, s90, 0
    s_add_u32 s77, s76, 12288
    buffer_load_dwordx4 v248, s[52:55], s77 offen offset:2048 lds
    s_add_u32 m0, s90, 0
    s_add_u32 s77, s76, 18432
    buffer_load_dwordx4 v249, s[52:55], s77 offen offset:3072 lds
    s_add_u32 s76, s91, 4
    s_cmp_ge_u32 s76, 7
    s_cselect_b32 s52, s28, s26
    s_cselect_b32 s53, s29, s27
    s_cselect_b32 s77, 7, 0
    s_sub_u32 s76, s76, s77
    s_lshl_b32 s76, s76, 7
    s_and_b32 s53, s53, 0xffff
    s_add_u32 m0, s90, 4096
    s_add_u32 s77, s76, 28672
    buffer_load_dwordx4 v248, s[52:55], s77 offen offset:0 lds
    s_add_u32 m0, s90, 4096
    s_add_u32 s77, s76, 34816
    buffer_load_dwordx4 v249, s[52:55], s77 offen offset:1024 lds
    s_add_u32 s76, s91, 4
    s_cmp_ge_u32 s76, 7
    s_cselect_b32 s52, s28, s26
    s_cselect_b32 s53, s29, s27
    s_cselect_b32 s77, 7, 0
    s_sub_u32 s76, s76, s77
    s_lshl_b32 s76, s76, 7
    s_and_b32 s53, s53, 0xffff
    s_add_u32 m0, s90, 4096
    s_add_u32 s77, s76, 40960
    buffer_load_dwordx4 v248, s[52:55], s77 offen offset:2048 lds
    s_add_u32 m0, s90, 4096
    s_add_u32 s77, s76, 47104
    buffer_load_dwordx4 v249, s[52:55], s77 offen offset:3072 lds
    s_lshl_b32 s3, s88, 1
    s_mul_i32 s3, s3, 56
    s_add_u32 s3, s3, s94
    s_lshl_b32 s3, s3, 10
    s_add_u32 s73, s3, 10485760
    s_cmp_lg_u32 s66, 7
    s_cbranch_scc1 L_NPH
    s_lshr_b32 s3, s88, 1
    s_lshl_b32 s3, s3, 8
    s_add_u32 s3, s3, 14794816
    v_lshlrev_b32 v33, 4, v1
    s_mov_b32 s93, 0
    v_cmp_eq_u32 s[6:7], 3, v1
    v_mov_b32 v34, 162820
    s_mov_b64 exec, 15
L_FPH:
    buffer_load_dwordx4 v[36:39], v33, s[60:63], s3 offen sc0 sc1
    s_waitcnt vmcnt(0)
    v_cndmask_b32 v38, v38, 1, s[6:7]
    v_cndmask_b32 v39, v39, 1, s[6:7]
    v_and_b32 v36, v36, v37
    v_and_b32 v38, v38, v39
    v_and_b32 v36, v36, v38
    v_cmp_ne_u32 vcc, 1, v36
    s_add_u32 s93, s93, 1
    s_nop 0
    s_cmp_eq_u32 vcc_lo, 0
    s_cbranch_scc1 L_FPHOK
    s_cmp_lt_u32 s93, 0x40000
    s_cbranch_scc1 L_FPH
L_FPHOK:
    v_mov_b32 v36, 1
    ds_write_b32 v34, v36
    s_mov_b64 exec, -1
L_NPH:
    v_mov_b32 v6, 162820
L_SPINS:
    ds_read_b32 v7, v6
    s_waitcnt lgkmcnt(0)
    v_readfirstlane_b32 s3, v7
    s_nop 0
    s_cmp_lg_u32 s3, 0
    s_cbranch_scc1 L_GOS
    s_sleep 1
    s_branch L_SPINS
L_GOS:
    s_add_u32 s75, s73, 0
    s_add_u32 s74, s75, 57344
    buffer_load_dwordx4 v[112:115], v8, s[60:63], s75 offen offset:0 sc1
    buffer_load_dwordx4 v[116:119], v8, s[60:63], s74 offen offset:0 sc1
    buffer_load_dwordx4 v[120:123], v8, s[60:63], s75 offen offset:1024 sc1
    buffer_load_dwordx4 v[124:127], v8, s[60:63], s74 offen offset:1024 sc1
    buffer_load_dwordx4 v[128:131], v8, s[60:63], s75 offen offset:2048 sc1
    buffer_load_dwordx4 v[132:135], v8, s[60:63], s74 offen offset:2048 sc1
    buffer_load_dwordx4 v[136:139], v8, s[60:63], s75 offen offset:3072 sc1
    buffer_load_dwordx4 v[140:143], v8, s[60:63], s74 offen offset:3072 sc1
    s_add_u32 s75, s73, 4096
    s_add_u32 s74, s75, 57344
    buffer_load_dwordx4 v[144:147], v8, s[60:63], s75 offen offset:0 sc1
    buffer_load_dwordx4 v[148:151], v8, s[60:63], s74 offen offset:0 sc1
    s_waitcnt vmcnt(8)
    v_mfma_f32_32x32x16_bf16 v[48:63], v[152:155], v[112:115], 0
    v_mfma_f32_32x32x16_bf16 v[64:79], v[152:155], v[116:119], 0
    v_mfma_f32_32x32x16_bf16 v[80:95], v[156:159], v[112:115], 0
    v_mfma_f32_32x32x16_bf16 v[96:111], v[156:159], v[116:119], 0
    buffer_load_dwordx4 v[112:115], v8, s[60:63], s75 offen offset:1024 sc1
    buffer_load_dwordx4 v[116:119], v8, s[60:63], s74 offen offset:1024 sc1
    s_waitcnt vmcnt(8)
    v_mfma_f32_32x32x16_bf16 v[48:63], v[160:163], v[120:123], v[48:63]
    v_mfma_f32_32x32x16_bf16 v[64:79], v[160:163], v[124:127], v[64:79]
    v_mfma_f32_32x32x16_bf16 v[80:95], v[164:167], v[120:123], v[80:95]
    v_mfma_f32_32x32x16_bf16 v[96:111], v[164:167], v[124:127], v[96:111]
    buffer_load_dwordx4 v[120:123], v8, s[60:63], s75 offen offset:2048 sc1
    buffer_load_dwordx4 v[124:127], v8, s[60:63], s74 offen offset:2048 sc1
    s_waitcnt vmcnt(8)
    v_mfma_f32_32x32x16_bf16 v[48:63], v[168:171], v[128:131], v[48:63]
    v_mfma_f32_32x32x16_bf16 v[64:79], v[168:171], v[132:135], v[64:79]
    v_mfma_f32_32x32x16_bf16 v[80:95], v[172:175], v[128:131], v[80:95]
    v_mfma_f32_32x32x16_bf16 v[96:111], v[172:175], v[132:135], v[96:111]
    buffer_load_dwordx4 v[128:131], v8, s[60:63], s75 offen offset:3072 sc1
    buffer_load_dwordx4 v[132:135], v8, s[60:63], s74 offen offset:3072 sc1
    s_waitcnt vmcnt(8)
    v_mfma_f32_32x32x16_bf16 v[48:63], v[176:179], v[136:139], v[48:63]
    v_mfma_f32_32x32x16_bf16 v[64:79], v[176:179], v[140:143], v[64:79]
    v_mfma_f32_32x32x16_bf16 v[80:95], v[180:183], v[136:139], v[80:95]
    v_mfma_f32_32x32x16_bf16 v[96:111], v[180:183], v[140:143], v[96:111]
    s_add_u32 s75, s73, 8192
    s_add_u32 s74, s75, 57344
    buffer_load_dwordx4 v[136:139], v8, s[60:63], s75 offen offset:0 sc1
    buffer_load_dwordx4 v[140:143], v8, s[60:63], s74 offen offset:0 sc1
    s_waitcnt vmcnt(8)
    v_mfma_f32_32x32x16_bf16 v[48:63], v[184:187], v[144:147], v[48:63]
    v_mfma_f32_32x32x16_bf16 v[64:79], v[184:187], v[148:151], v[64:79]
    v_mfma_f32_32x32x16_bf16 v[80:95], v[188:191], v[144:147], v[80:95]
    v_mfma_f32_32x32x16_bf16 v[96:111], v[188:191], v[148:151], v[96:111]
    buffer_load_dwordx4 v[144:147], v8, s[60:63], s75 offen offset:1024 sc1
    buffer_load_dwordx4 v[148:151], v8, s[60:63], s74 offen offset:1024 sc1
    s_waitcnt vmcnt(8)
    v_mfma_f32_32x32x16_bf16 v[48:63], v[192:195], v[112:115], v[48:63]
    v_mfma_f32_32x32x16_bf16 v[64:79], v[192:195], v[116:119], v[64:79]
    v_mfma_f32_32x32x16_bf16 v[80:95], v[196:199], v[112:115], v[80:95]
    v_mfma_f32_32x32x16_bf16 v[96:111], v[196:199], v[116:119], v[96:111]
    buffer_load_dwordx4 v[112:115], v8, s[60:63], s75 offen offset:2048 sc1
    buffer_load_dwordx4 v[116:119], v8, s[60:63], s74 offen offset:2048 sc1
    s_waitcnt vmcnt(8)
    v_mfma_f32_32x32x16_bf16 v[48:63], v[200:203], v[120:123], v[48:63]
    v_mfma_f32_32x32x16_bf16 v[64:79], v[200:203], v[124:127], v[64:79]
    v_mfma_f32_32x32x16_bf16 v[80:95], v[204:207], v[120:123], v[80:95]
    v_mfma_f32_32x32x16_bf16 v[96:111], v[204:207], v[124:127], v[96:111]
    buffer_load_dwordx4 v[120:123], v8, s[60:63], s75 offen offset:3072 sc1
    buffer_load_dwordx4 v[124:127], v8, s[60:63], s74 offen offset:3072 sc1
    s_waitcnt vmcnt(8)
    v_mfma_f32_32x32x16_bf16 v[48:63], v[208:211], v[128:131], v[48:63]
    v_mfma_f32_32x32x16_bf16 v[64:79], v[208:211], v[132:135], v[64:79]
    v_mfma_f32_32x32x16_bf16 v[80:95], v[212:215], v[128:131], v[80:95]
    v_mfma_f32_32x32x16_bf16 v[96:111], v[212:215], v[132:135], v[96:111]
    s_add_u32 s75, s73, 12288
    s_add_u32 s74, s75, 57344
    buffer_load_dwordx4 v[128:131], v8, s[60:63], s75 offen offset:0 sc1
    buffer_load_dwordx4 v[132:135], v8, s[60:63], s74 offen offset:0 sc1
    s_waitcnt vmcnt(8)
    v_mfma_f32_32x32x16_bf16 v[48:63], v[216:219], v[136:139], v[48:63]
    v_mfma_f32_32x32x16_bf16 v[64:79], v[216:219], v[140:143], v[64:79]
    v_mfma_f32_32x32x16_bf16 v[80:95], v[220:223], v[136:139], v[80:95]
    v_mfma_f32_32x32x16_bf16 v[96:111], v[220:223], v[140:143], v[96:111]
    buffer_load_dwordx4 v[136:139], v8, s[60:63], s75 offen offset:1024 sc1
    buffer_load_dwordx4 v[140:143], v8, s[60:63], s74 offen offset:1024 sc1
    s_waitcnt vmcnt(8)
    v_mfma_f32_32x32x16_bf16 v[48:63], v[224:227], v[144:147], v[48:63]
    v_mfma_f32_32x32x16_bf16 v[64:79], v[224:227], v[148:151], v[64:79]
    v_mfma_f32_32x32x16_bf16 v[80:95], v[228:231], v[144:147], v[80:95]
    v_mfma_f32_32x32x16_bf16 v[96:111], v[228:231], v[148:151], v[96:111]
    buffer_load_dwordx4 v[144:147], v8, s[60:63], s75 offen offset:2048 sc1
    buffer_load_dwordx4 v[148:151], v8, s[60:63], s74 offen offset:2048 sc1
    s_waitcnt vmcnt(8)
    v_mfma_f32_32x32x16_bf16 v[48:63], v[232:235], v[112:115], v[48:63]
    v_mfma_f32_32x32x16_bf16 v[64:79], v[232:235], v[116:119], v[64:79]
    v_mfma_f32_32x32x16_bf16 v[80:95], v[236:239], v[112:115], v[80:95]
    v_mfma_f32_32x32x16_bf16 v[96:111], v[236:239], v[116:119], v[96:111]
    buffer_load_dwordx4 v[112:115], v8, s[60:63], s75 offen offset:3072 sc1
    buffer_load_dwordx4 v[116:119], v8, s[60:63], s74 offen offset:3072 sc1
    ds_read_b128 v[32:35], v250 offset:8192
    ds_read_b128 v[36:39], v250 offset:12288
    s_waitcnt vmcnt(8)
    v_mfma_f32_32x32x16_bf16 v[48:63], v[240:243], v[120:123], v[48:63]
    v_mfma_f32_32x32x16_bf16 v[64:79], v[240:243], v[124:127], v[64:79]
    v_mfma_f32_32x32x16_bf16 v[80:95], v[244:247], v[120:123], v[80:95]
    v_mfma_f32_32x32x16_bf16 v[96:111], v[244:247], v[124:127], v[96:111]
    s_add_u32 s75, s73, 16384
    s_add_u32 s74, s75, 57344
    buffer_load_dwordx4 v[120:123], v8, s[60:63], s75 offen offset:0 sc1
    buffer_load_dwordx4 v[124:127], v8, s[60:63], s74 offen offset:0 sc1
    ds_read_b128 v[40:43], v251 offset:8192
    ds_read_b128 v[44:47], v251 offset:12288
    s_waitcnt vmcnt(8)
    s_waitcnt lgkmcnt(2)
    v_mfma_f32_32x32x16_bf16 v[48:63], v[32:35], v[128:131], v[48:63]
    v_mfma_f32_32x32x16_bf16 v[64:79], v[32:35], v[132:135], v[64:79]
    v_mfma_f32_32x32x16_bf16 v[80:95], v[36:39], v[128:131], v[80:95]
    v_mfma_f32_32x32x16_bf16 v[96:111], v[36:39], v[132:135], v[96:111]
    buffer_load_dwordx4 v[128:131], v8, s[60:63], s75 offen offset:1024 sc1
    buffer_load_dwordx4 v[132:135], v8, s[60:63], s74 offen offset:1024 sc1
    ds_read_b128 v[32:35], v252 offset:8192
    ds_read_b128 v[36:39], v252 offset:12288
    s_waitcnt vmcnt(8)
    s_waitcnt lgkmcnt(2)
    v_mfma_f32_32x32x16_bf16 v[48:63], v[40:43], v[136:139], v[48:63]
    v_mfma_f32_32x32x16_bf16 v[64:79], v[40:43], v[140:143], v[64:79]
    v_mfma_f32_32x32x16_bf16 v[80:95], v[44:47], v[136:139], v[80:95]
    v_mfma_f32_32x32x16_bf16 v[96:111], v[44:47], v[140:143], v[96:111]
    buffer_load_dwordx4 v[136:139], v8, s[60:63], s75 offen offset:2048 sc1
    buffer_load_dwordx4 v[140:143], v8, s[60:63], s74 offen offset:2048 sc1
    ds_read_b128 v[40:43], v253 offset:8192
    ds_read_b128 v[44:47], v253 offset:12288
    s_waitcnt vmcnt(8)
    s_waitcnt lgkmcnt(2)
    v_mfma_f32_32x32x16_bf16 v[48:63], v[32:35], v[144:147], v[48:63]
    v_mfma_f32_32x32x16_bf16 v[64:79], v[32:35], v[148:151], v[64:79]
    v_mfma_f32_32x32x16_bf16 v[80:95], v[36:39], v[144:147], v[80:95]
    v_mfma_f32_32x32x16_bf16 v[96:111], v[36:39], v[148:151], v[96:111]
    buffer_load_dwordx4 v[144:147], v8, s[60:63], s75 offen offset:3072 sc1
    buffer_load_dwordx4 v[148:151], v8, s[60:63], s74 offen offset:3072 sc1
    ds_read_b128 v[32:35], v250 offset:0
    ds_read_b128 v[36:39], v250 offset:4096
    s_waitcnt vmcnt(8)
    s_waitcnt lgkmcnt(2)
    v_mfma_f32_32x32x16_bf16 v[48:63], v[40:43], v[112:115], v[48:63]
    v_mfma_f32_32x32x16_bf16 v[64:79], v[40:43], v[116:119], v[64:79]
    v_mfma_f32_32x32x16_bf16 v[80:95], v[44:47], v[112:115], v[80:95]
    v_mfma_f32_32x32x16_bf16 v[96:111], v[44:47], v[116:119], v[96:111]
    s_cmp_eq_u32 s66, 7
    s_cbranch_scc1 L_DONES
    ds_read_b128 v[40:43], v251 offset:0
    ds_read_b128 v[44:47], v251 offset:4096
    s_waitcnt vmcnt(6)
    s_waitcnt lgkmcnt(2)
    v_mfma_f32_32x32x16_bf16 v[48:63], v[32:35], v[120:123], v[48:63]
    v_mfma_f32_32x32x16_bf16 v[64:79], v[32:35], v[124:127], v[64:79]
    v_mfma_f32_32x32x16_bf16 v[80:95], v[36:39], v[120:123], v[80:95]
    v_mfma_f32_32x32x16_bf16 v[96:111], v[36:39], v[124:127], v[96:111]
    ds_read_b128 v[32:35], v252 offset:0
    ds_read_b128 v[36:39], v252 offset:4096
    s_waitcnt vmcnt(4)
    s_waitcnt lgkmcnt(2)
    v_mfma_f32_32x32x16_bf16 v[48:63], v[40:43], v[128:131], v[48:63]
    v_mfma_f32_32x32x16_bf16 v[64:79], v[40:43], v[132:135], v[64:79]
    v_mfma_f32_32x32x16_bf16 v[80:95], v[44:47], v[128:131], v[80:95]
    v_mfma_f32_32x32x16_bf16 v[96:111], v[44:47], v[132:135], v[96:111]
    ds_read_b128 v[40:43], v253 offset:0
    ds_read_b128 v[44:47], v253 offset:4096
    s_waitcnt vmcnt(2)
    s_waitcnt lgkmcnt(2)
    v_mfma_f32_32x32x16_bf16 v[48:63], v[32:35], v[136:139], v[48:63]
    v_mfma_f32_32x32x16_bf16 v[64:79], v[32:35], v[140:143], v[64:79]
    v_mfma_f32_32x32x16_bf16 v[80:95], v[36:39], v[136:139], v[80:95]
    v_mfma_f32_32x32x16_bf16 v[96:111], v[36:39], v[140:143], v[96:111]
    s_waitcnt vmcnt(0)
    s_waitcnt lgkmcnt(0)
    v_mfma_f32_32x32x16_bf16 v[48:63], v[40:43], v[144:147], v[48:63]
    v_mfma_f32_32x32x16_bf16 v[64:79], v[40:43], v[148:151], v[64:79]
    v_mfma_f32_32x32x16_bf16 v[80:95], v[44:47], v[144:147], v[80:95]
    v_mfma_f32_32x32x16_bf16 v[96:111], v[44:47], v[148:151], v[96:111]
L_DONES:
    s_waitcnt vmcnt(0) lgkmcnt(0)
    v_and_b32 v2, 31, v1
    v_lshrrev_b32 v3, 5, v1
    v_and_b32 v4, 15, v1
    v_xor_b32 v3, v3, v4
    v_lshlrev_b32 v3, 4, v3
    v_lshl_add_u32 v2, v2, 8, v3
    v_add_u32 v2, s90, v2
    v_xor_b32 v136, 0, v2
    v_xor_b32 v137, 32, v2
    v_xor_b32 v138, 64, v2
    v_xor_b32 v139, 96, v2
    v_xor_b32 v140, 128, v2
    v_xor_b32 v141, 160, v2
    v_xor_b32 v142, 192, v2
    v_xor_b32 v143, 224, v2
    s_nop 7
    ds_write_b128 v136, v[48:51] offset:0
    ds_write_b128 v137, v[52:55] offset:0
    ds_write_b128 v138, v[56:59] offset:0
    ds_write_b128 v139, v[60:63] offset:0
    ds_write_b128 v136, v[64:67] offset:8192
    ds_write_b128 v137, v[68:71] offset:8192
    ds_write_b128 v138, v[72:75] offset:8192
    ds_write_b128 v139, v[76:79] offset:8192
    ds_write_b128 v140, v[80:83] offset:0
    ds_write_b128 v141, v[84:87] offset:0
    ds_write_b128 v142, v[88:91] offset:0
    ds_write_b128 v143, v[92:95] offset:0
    ds_write_b128 v140, v[96:99] offset:8192
    ds_write_b128 v141, v[100:103] offset:8192
    ds_write_b128 v142, v[104:107] offset:8192
    ds_write_b128 v143, v[108:111] offset:8192
L_FIN:
    v_lshlrev_b32 v24, 16, v30
    v_and_b32 v25, 0xffff0000, v30
    v_lshlrev_b32 v26, 16, v31
    v_and_b32 v27, 0xffff0000, v31
    v_lshlrev_b32 v112, 16, v10
    v_and_b32 v113, 0xffff0000, v10
    v_lshlrev_b32 v114, 16, v11
    v_and_b32 v115, 0xffff0000, v11
    v_sub_f32 v116, v112, v12
    v_sub_f32 v117, v113, v12
    v_sub_f32 v118, v114, v12
    v_sub_f32 v119, v115, v12
    v_cvt_pk_bf16_f32 v116, 0, v116
    v_cvt_pk_bf16_f32 v117, 0, v117
    v_cvt_pk_bf16_f32 v118, 0, v118
    v_cvt_pk_bf16_f32 v119, 0, v119
    v_mul_f32 v128, v116, v13
    v_mul_f32 v129, v117, v13
    v_mul_f32 v130, v118, v13
    v_mul_f32 v131, v119, v13
    v_fma_f32 v116, -v128, v14, v116
    v_fma_f32 v117, -v129, v14, v117
    v_fma_f32 v118, -v130, v14, v118
    v_fma_f32 v119, -v131, v14, v119
    v_fma_f32 v116, v116, v13, v128
    v_fma_f32 v117, v117, v13, v129
    v_fma_f32 v118, v118, v13, v130
    v_fma_f32 v119, v119, v13, v131
    v_cvt_pk_bf16_f32 v116, 0, v116
    v_cvt_pk_bf16_f32 v117, 0, v117
    v_cvt_pk_bf16_f32 v118, 0, v118
    v_cvt_pk_bf16_f32 v119, 0, v119
    v_mul_f32 v116, v116, v24
    v_mul_f32 v117, v117, v25
    v_mul_f32 v118, v118, v26
    v_mul_f32 v119, v119, v27
    v_cvt_pk_bf16_f32 v116, 0, v116
    v_cvt_pk_bf16_f32 v117, 0, v117
    v_cvt_pk_bf16_f32 v118, 0, v118
    v_cvt_pk_bf16_f32 v119, 0, v119
    v_mul_f32 v28, v13, v13
    v_lshlrev_b32 v120, 16, v16
    v_and_b32 v121, 0xffff0000, v16
    v_lshlrev_b32 v122, 16, v17
    v_and_b32 v123, 0xffff0000, v17
    v_sub_f32 v124, v120, v18
    v_sub_f32 v125, v121, v18
    v_sub_f32 v126, v122, v18
    v_sub_f32 v127, v123, v18
    v_cvt_pk_bf16_f32 v124, 0, v124
    v_cvt_pk_bf16_f32 v125, 0, v125
    v_cvt_pk_bf16_f32 v126, 0, v126
    v_cvt_pk_bf16_f32 v127, 0, v127
    v_mul_f32 v128, v124, v19
    v_mul_f32 v129, v125, v19
    v_mul_f32 v130, v126, v19
    v_mul_f32 v131, v127, v19
    v_fma_f32 v124, -v128, v20, v124
    v_fma_f32 v125, -v129, v20, v125
    v_fma_f32 v126, -v130, v20, v126
    v_fma_f32 v127, -v131, v20, v127
    v_fma_f32 v124, v124, v19, v128
    v_fma_f32 v125, v125, v19, v129
    v_fma_f32 v126, v126, v19, v130
    v_fma_f32 v127, v127, v19, v131
    v_cvt_pk_bf16_f32 v124, 0, v124
    v_cvt_pk_bf16_f32 v125, 0, v125
    v_cvt_pk_bf16_f32 v126, 0, v126
    v_cvt_pk_bf16_f32 v127, 0, v127
    v_mul_f32 v124, v124, v24
    v_mul_f32 v125, v125, v25
    v_mul_f32 v126, v126, v26
    v_mul_f32 v127, v127, v27
    v_cvt_pk_bf16_f32 v124, 0, v124
    v_cvt_pk_bf16_f32 v125, 0, v125
    v_cvt_pk_bf16_f32 v126, 0, v126
    v_cvt_pk_bf16_f32 v127, 0, v127
    v_mul_f32 v29, v19, v19
    s_lshl_b32 s3, s66, 1
    s_add_u32 s3, s3, 0
    v_lshrrev_b32 v2, 4, v1
    v_lshlrev_b32 v2, 12, v2
    v_and_b32 v3, 15, v1
    v_xor_b32 v3, s3, v3
    v_lshl_add_u32 v2, v3, 4, v2
    s_lshl_b32 s3, s3, 8
    v_add_u32 v4, s3, v2
    v_add_u32 v5, 0x10000, v4
    s_lshl_b32 s3, s66, 1
    s_add_u32 s3, s3, 1
    v_lshrrev_b32 v2, 4, v1
    v_lshlrev_b32 v2, 12, v2
    v_and_b32 v3, 15, v1
    v_xor_b32 v3, s3, v3
    v_lshl_add_u32 v2, v3, 4, v2
    s_lshl_b32 s3, s3, 8
    v_add_u32 v6, s3, v2
    v_add_u32 v7, 0x10000, v6
    s_waitcnt lgkmcnt(0)
    s_barrier
    ds_read_b128 v[152:155], v4 offset:0
    ds_read_b128 v[156:159], v4 offset:16384
    ds_read_b128 v[160:163], v4 offset:32768
    ds_read_b128 v[164:167], v4 offset:49152
    ds_read_b128 v[168:171], v5 offset:0
    ds_read_b128 v[172:175], v5 offset:16384
    ds_read_b128 v[176:179], v5 offset:32768
    ds_read_b128 v[180:183], v5 offset:49152
    ds_read_b128 v[184:187], v6 offset:0
    ds_read_b128 v[188:191], v6 offset:16384
    ds_read_b128 v[192:195], v6 offset:32768
    ds_read_b128 v[196:199], v6 offset:49152
    ds_read_b128 v[200:203], v7 offset:0
    ds_read_b128 v[204:207], v7 offset:16384
    ds_read_b128 v[208:211], v7 offset:32768
    ds_read_b128 v[212:215], v7 offset:49152
    s_waitcnt lgkmcnt(8)
    v_add_f32 v152, v152, v156
    v_add_f32 v153, v153, v157
    v_add_f32 v154, v154, v158
    v_add_f32 v155, v155, v159
    v_add_f32 v160, v160, v164
    v_add_f32 v161, v161, v165
    v_add_f32 v162, v162, v166
    v_add_f32 v163, v163, v167
    v_add_f32 v172, v172, v176
    v_add_f32 v173, v173, v177
    v_add_f32 v174, v174, v178
    v_add_f32 v175, v175, v179
    v_add_f32 v152, v152, v168
    v_add_f32 v153, v153, v169
    v_add_f32 v154, v154, v170
    v_add_f32 v155, v155, v171
    v_add_f32 v180, v180, v116
    v_add_f32 v181, v181, v117
    v_add_f32 v182, v182, v118
    v_add_f32 v183, v183, v119
    v_add_f32 v152, v152, v160
    v_add_f32 v153, v153, v161
    v_add_f32 v154, v154, v162
    v_add_f32 v155, v155, v163
    v_add_f32 v172, v172, v180
    v_add_f32 v173, v173, v181
    v_add_f32 v174, v174, v182
    v_add_f32 v175, v175, v183
    v_mul_f32 v152, v152, v28
    v_mul_f32 v153, v153, v28
    v_mul_f32 v154, v154, v28
    v_mul_f32 v155, v155, v28
    v_cvt_pk_bf16_f32 v152, 0, v152
    v_cvt_pk_bf16_f32 v153, 0, v153
    v_cvt_pk_bf16_f32 v154, 0, v154
    v_cvt_pk_bf16_f32 v155, 0, v155
    v_mul_f32 v156, 3216550459, v152
    v_mul_f32 v157, 3216550459, v153
    v_mul_f32 v158, 3216550459, v154
    v_mul_f32 v159, 3216550459, v155
    v_exp_f32 v156, v156
    v_exp_f32 v157, v157
    v_exp_f32 v158, v158
    v_exp_f32 v159, v159
    v_add_f32 v156, 1.0, v156
    v_add_f32 v157, 1.0, v157
    v_add_f32 v158, 1.0, v158
    v_add_f32 v159, 1.0, v159
    v_rcp_f32 v156, v156
    v_rcp_f32 v157, v157
    v_rcp_f32 v158, v158
    v_rcp_f32 v159, v159
    v_mul_f32 v152, v152, v156
    v_mul_f32 v153, v153, v157
    v_mul_f32 v154, v154, v158
    v_mul_f32 v155, v155, v159
    v_cvt_pk_bf16_f32 v152, 0, v152
    v_cvt_pk_bf16_f32 v153, 0, v153
    v_cvt_pk_bf16_f32 v154, 0, v154
    v_cvt_pk_bf16_f32 v155, 0, v155
    v_fma_f32 v160, v152, v172, v112
    v_fma_f32 v161, v153, v173, v113
    v_fma_f32 v162, v154, v174, v114
    v_fma_f32 v163, v155, v175, v115
    buffer_store_dwordx4 v[160:163], v22, s[68:71], 0 offen sc0 sc1
    s_waitcnt lgkmcnt(0)
    v_add_f32 v184, v184, v188
    v_add_f32 v185, v185, v189
    v_add_f32 v186, v186, v190
    v_add_f32 v187, v187, v191
    v_add_f32 v192, v192, v196
    v_add_f32 v193, v193, v197
    v_add_f32 v194, v194, v198
    v_add_f32 v195, v195, v199
    v_add_f32 v204, v204, v208
    v_add_f32 v205, v205, v209
    v_add_f32 v206, v206, v210
    v_add_f32 v207, v207, v211
    v_add_f32 v184, v184, v200
    v_add_f32 v185, v185, v201
    v_add_f32 v186, v186, v202
    v_add_f32 v187, v187, v203
    v_add_f32 v212, v212, v124
    v_add_f32 v213, v213, v125
    v_add_f32 v214, v214, v126
    v_add_f32 v215, v215, v127
    v_add_f32 v184, v184, v192
    v_add_f32 v185, v185, v193
    v_add_f32 v186, v186, v194
    v_add_f32 v187, v187, v195
    v_add_f32 v204, v204, v212
    v_add_f32 v205, v205, v213
    v_add_f32 v206, v206, v214
    v_add_f32 v207, v207, v215
    v_mul_f32 v184, v184, v29
    v_mul_f32 v185, v185, v29
    v_mul_f32 v186, v186, v29
    v_mul_f32 v187, v187, v29
    v_cvt_pk_bf16_f32 v184, 0, v184
    v_cvt_pk_bf16_f32 v185, 0, v185
    v_cvt_pk_bf16_f32 v186, 0, v186
    v_cvt_pk_bf16_f32 v187, 0, v187
    v_mul_f32 v188, 3216550459, v184
    v_mul_f32 v189, 3216550459, v185
    v_mul_f32 v190, 3216550459, v186
    v_mul_f32 v191, 3216550459, v187
    v_exp_f32 v188, v188
    v_exp_f32 v189, v189
    v_exp_f32 v190, v190
    v_exp_f32 v191, v191
    v_add_f32 v188, 1.0, v188
    v_add_f32 v189, 1.0, v189
    v_add_f32 v190, 1.0, v190
    v_add_f32 v191, 1.0, v191
    v_rcp_f32 v188, v188
    v_rcp_f32 v189, v189
    v_rcp_f32 v190, v190
    v_rcp_f32 v191, v191
    v_mul_f32 v184, v184, v188
    v_mul_f32 v185, v185, v189
    v_mul_f32 v186, v186, v190
    v_mul_f32 v187, v187, v191
    v_cvt_pk_bf16_f32 v184, 0, v184
    v_cvt_pk_bf16_f32 v185, 0, v185
    v_cvt_pk_bf16_f32 v186, 0, v186
    v_cvt_pk_bf16_f32 v187, 0, v187
    v_fma_f32 v192, v184, v204, v120
    v_fma_f32 v193, v185, v205, v121
    v_fma_f32 v194, v186, v206, v122
    v_fma_f32 v195, v187, v207, v123
    buffer_store_dwordx4 v[192:195], v23, s[68:71], 0 offen sc0 sc1
    s_endpgm
L_SPARE:
    s_mov_b32 s64, s2
    v_and_b32 v3, 31, v1
    v_lshrrev_b32 v2, 5, v1
    s_waitcnt lgkmcnt(0)
    s_mov_b32 s60, s46
    s_and_b32 s61, s47, 0xffff
    s_mov_b32 s62, 16777216
    s_mov_b32 s63, 0x20000
    s_mov_b32 s12, s44
    s_and_b32 s13, s45, 0xffff
    s_mov_b32 s14, 256
    s_mov_b32 s15, 0x20000
    s_cmp_ge_u32 s66, 4
    s_cbranch_scc1 L_SPW
    s_mov_b32 s8, s16
    s_and_b32 s9, s17, 0xffff
    s_mov_b32 s10, 1835008
    s_mov_b32 s11, 0x20000
    s_cmp_lt_u32 s64, 16
    s_cselect_b32 s56, s22, s24
    s_cselect_b32 s57, s23, s25
    s_and_b32 s57, s57, 0xffff
    s_mov_b32 s58, 401408
    s_mov_b32 s59, 0x20000
    v_mov_b32 v40, 0
    v_mov_b32 v41, 0
    v_mov_b32 v42, 0
    v_mov_b32 v43, 0
    v_mov_b32 v44, 0
    v_mov_b32 v45, 0
    v_mov_b32 v46, 0
    v_mov_b32 v47, 0
    v_mov_b32 v48, 0
    v_mov_b32 v49, 0
    v_mov_b32 v50, 0
    v_mov_b32 v51, 0
    v_mov_b32 v52, 0
    v_mov_b32 v53, 0
    v_mov_b32 v54, 0
    v_mov_b32 v55, 0
    v_mov_b32 v56, 0
    v_mov_b32 v57, 0
    v_mov_b32 v58, 0
    v_mov_b32 v59, 0
    v_mov_b32 v60, 0
    v_mov_b32 v61, 0
    v_mov_b32 v62, 0
    v_mov_b32 v63, 0
    v_mov_b32 v64, 0
    v_mov_b32 v65, 0
    v_mov_b32 v66, 0
    v_mov_b32 v67, 0
    v_mov_b32 v68, 0
    v_mov_b32 v69, 0
    v_mov_b32 v70, 0
    v_mov_b32 v71, 0
    v_mov_b32 v72, 0
    v_mov_b32 v73, 0
    v_mov_b32 v74, 0
    v_mov_b32 v75, 0
    v_mov_b32 v76, 0
    v_mov_b32 v77, 0
    v_mov_b32 v78, 0
    v_mov_b32 v79, 0
    v_mov_b32 v80, 0
    v_mov_b32 v81, 0
    v_mov_b32 v82, 0
    v_mov_b32 v83, 0
    v_mov_b32 v84, 0
    v_mov_b32 v85, 0
    v_mov_b32 v86, 0
    v_mov_b32 v87, 0
    v_mov_b32 v88, 0
    v_mov_b32 v89, 0
    v_mov_b32 v90, 0
    v_mov_b32 v91, 0
    v_mov_b32 v92, 0
    v_mov_b32 v93, 0
    v_mov_b32 v94, 0
    v_mov_b32 v95, 0
    v_mov_b32 v96, 0
    v_mov_b32 v97, 0
    v_mov_b32 v98, 0
    v_mov_b32 v99, 0
    v_mov_b32 v100, 0
    v_mov_b32 v101, 0
    v_mov_b32 v102, 0
    v_mov_b32 v103, 0
    v_mov_b32 v104, 0
    v_mov_b32 v105, 0
    v_mov_b32 v106, 0
    v_mov_b32 v107, 0
    v_mov_b32 v108, 0
    v_mov_b32 v109, 0
    v_mov_b32 v110, 0
    v_mov_b32 v111, 0
    v_mov_b32 v112, 0
    v_mov_b32 v113, 0
    v_mov_b32 v114, 0
    v_mov_b32 v115, 0
    v_mov_b32 v116, 0
    v_mov_b32 v117, 0
    v_mov_b32 v118, 0
    v_mov_b32 v119, 0
    v_mov_b32 v120, 0
    v_mov_b32 v121, 0
    v_mov_b32 v122, 0
    v_mov_b32 v123, 0
    v_mov_b32 v124, 0
    v_mov_b32 v125, 0
    v_mov_b32 v126, 0
    v_mov_b32 v127, 0
    v_mov_b32 v128, 0
    v_mov_b32 v129, 0
    v_mov_b32 v130, 0
    v_mov_b32 v131, 0
    v_mov_b32 v132, 0
    v_mov_b32 v133, 0
    v_mov_b32 v134, 0
    v_mov_b32 v135, 0
    s_and_b32 s3, s64, 7
    s_lshr_b32 s3, s3, 1
    s_lshl_b32 s3, s3, 3
    s_lshr_b32 s4, s64, 3
    s_lshl_b32 s4, s4, 1
    s_add_u32 s3, s3, s4
    s_and_b32 s4, s64, 1
    s_add_u32 s3, s3, s4
    s_lshl_b32 s3, s3, 6
    s_lshl_b32 s4, s66, 4
    s_add_u32 s65, s3, s4
    v_add_u32 v9, s65, v2
    v_mul_u32_u24 v10, 896, v9
    v_lshl_add_u32 v10, v3, 4, v10
    s_and_b32 s3, s64, 15
    s_mul_i32 s3, s3, 28
    s_lshl_b32 s5, s66, 3
    s_add_u32 s3, s3, s5
    v_add_u32 v11, s3, v2
    v_mul_u32_u24 v12, 896, v11
    v_lshl_add_u32 v12, v3, 4, v12
    v_cmp_gt_u32 vcc, 28, v3
    s_nop 0
    s_and_saveexec_b64 s[4:5], vcc
    s_mov_b64 s[6:7], exec
    s_movk_i32 s3, 0
    buffer_load_dwordx4 v[40:43], v10, s[8:11], s3 offen
    buffer_load_dwordx4 v[44:47], v10, s[8:11], s3 offen offset:448
    s_movk_i32 s3, 1792
    buffer_load_dwordx4 v[48:51], v10, s[8:11], s3 offen
    buffer_load_dwordx4 v[52:55], v10, s[8:11], s3 offen offset:448
    s_movk_i32 s3, 3584
    buffer_load_dwordx4 v[56:59], v10, s[8:11], s3 offen
    buffer_load_dwordx4 v[60:63], v10, s[8:11], s3 offen offset:448
    s_movk_i32 s3, 5376
    buffer_load_dwordx4 v[64:67], v10, s[8:11], s3 offen
    buffer_load_dwordx4 v[68:71], v10, s[8:11], s3 offen offset:448
    s_movk_i32 s3, 7168
    buffer_load_dwordx4 v[72:75], v10, s[8:11], s3 offen
    buffer_load_dwordx4 v[76:79], v10, s[8:11], s3 offen offset:448
    s_movk_i32 s3, 8960
    buffer_load_dwordx4 v[80:83], v10, s[8:11], s3 offen
    buffer_load_dwordx4 v[84:87], v10, s[8:11], s3 offen offset:448
    s_movk_i32 s3, 10752
    buffer_load_dwordx4 v[88:91], v10, s[8:11], s3 offen
    buffer_load_dwordx4 v[92:95], v10, s[8:11], s3 offen offset:448
    s_movk_i32 s3, 12544
    buffer_load_dwordx4 v[96:99], v10, s[8:11], s3 offen
    buffer_load_dwordx4 v[100:103], v10, s[8:11], s3 offen offset:448
    s_movk_i32 s3, 0
    buffer_load_dwordx4 v[104:107], v12, s[56:59], s3 offen
    buffer_load_dwordx4 v[108:111], v12, s[56:59], s3 offen offset:448
    s_movk_i32 s3, 1792
    buffer_load_dwordx4 v[112:115], v12, s[56:59], s3 offen
    buffer_load_dwordx4 v[116:119], v12, s[56:59], s3 offen offset:448
    s_movk_i32 s3, 3584
    buffer_load_dwordx4 v[120:123], v12, s[56:59], s3 offen
    buffer_load_dwordx4 v[124:127], v12, s[56:59], s3 offen offset:448
    s_movk_i32 s3, 5376
    buffer_load_dwordx4 v[128:131], v12, s[56:59], s3 offen
    buffer_load_dwordx4 v[132:135], v12, s[56:59], s3 offen offset:448
    s_mov_b64 exec, s[4:5]
    s_mov_b32 s70, 0x3f803f80
    s_waitcnt vmcnt(16)
    v_mov_b32 v16, 0
    v_mov_b32 v17, 0
    v_mov_b32 v18, 0
    v_mov_b32 v19, 0
    v_dot2c_f32_bf16 v16, s70, v40
    v_dot2c_f32_bf16 v17, s70, v48
    v_dot2c_f32_bf16 v18, s70, v56
    v_dot2c_f32_bf16 v19, s70, v64
    v_dot2c_f32_bf16 v16, s70, v41
    v_dot2c_f32_bf16 v17, s70, v49
    v_dot2c_f32_bf16 v18, s70, v57
    v_dot2c_f32_bf16 v19, s70, v65
    v_dot2c_f32_bf16 v16, s70, v42
    v_dot2c_f32_bf16 v17, s70, v50
    v_dot2c_f32_bf16 v18, s70, v58
    v_dot2c_f32_bf16 v19, s70, v66
    v_dot2c_f32_bf16 v16, s70, v43
    v_dot2c_f32_bf16 v17, s70, v51
    v_dot2c_f32_bf16 v18, s70, v59
    v_dot2c_f32_bf16 v19, s70, v67
    v_dot2c_f32_bf16 v16, s70, v44
    v_dot2c_f32_bf16 v17, s70, v52
    v_dot2c_f32_bf16 v18, s70, v60
    v_dot2c_f32_bf16 v19, s70, v68
    v_dot2c_f32_bf16 v16, s70, v45
    v_dot2c_f32_bf16 v17, s70, v53
    v_dot2c_f32_bf16 v18, s70, v61
    v_dot2c_f32_bf16 v19, s70, v69
    v_dot2c_f32_bf16 v16, s70, v46
    v_dot2c_f32_bf16 v17, s70, v54
    v_dot2c_f32_bf16 v18, s70, v62
    v_dot2c_f32_bf16 v19, s70, v70
    v_dot2c_f32_bf16 v16, s70, v47
    v_dot2c_f32_bf16 v17, s70, v55
    v_dot2c_f32_bf16 v18, s70, v63
    v_dot2c_f32_bf16 v19, s70, v71
    v_lshlrev_b32 v136, 16, v40
    v_and_b32 v137, 0xffff0000, v40
    v_lshlrev_b32 v138, 16, v41
    v_and_b32 v139, 0xffff0000, v41
    v_lshlrev_b32 v140, 16, v42
    v_and_b32 v141, 0xffff0000, v42
    v_lshlrev_b32 v142, 16, v43
    v_and_b32 v143, 0xffff0000, v43
    v_lshlrev_b32 v144, 16, v44
    v_and_b32 v145, 0xffff0000, v44
    v_lshlrev_b32 v146, 16, v45
    v_and_b32 v147, 0xffff0000, v45
    v_lshlrev_b32 v148, 16, v46
    v_and_b32 v149, 0xffff0000, v46
    v_lshlrev_b32 v150, 16, v47
    v_and_b32 v151, 0xffff0000, v47
    v_lshlrev_b32 v152, 16, v48
    v_and_b32 v153, 0xffff0000, v48
    v_lshlrev_b32 v154, 16, v49
    v_and_b32 v155, 0xffff0000, v49
    v_lshlrev_b32 v156, 16, v50
    v_and_b32 v157, 0xffff0000, v50
    v_lshlrev_b32 v158, 16, v51
    v_and_b32 v159, 0xffff0000, v51
    v_lshlrev_b32 v160, 16, v52
    v_and_b32 v161, 0xffff0000, v52
    v_lshlrev_b32 v162, 16, v53
    v_and_b32 v163, 0xffff0000, v53
    v_lshlrev_b32 v164, 16, v54
    v_and_b32 v165, 0xffff0000, v54
    v_lshlrev_b32 v166, 16, v55
    v_and_b32 v167, 0xffff0000, v55
    v_lshlrev_b32 v168, 16, v56
    v_and_b32 v169, 0xffff0000, v56
    v_lshlrev_b32 v170, 16, v57
    v_and_b32 v171, 0xffff0000, v57
    v_lshlrev_b32 v172, 16, v58
    v_and_b32 v173, 0xffff0000, v58
    v_lshlrev_b32 v174, 16, v59
    v_and_b32 v175, 0xffff0000, v59
    v_lshlrev_b32 v176, 16, v60
    v_and_b32 v177, 0xffff0000, v60
    v_lshlrev_b32 v178, 16, v61
    v_and_b32 v179, 0xffff0000, v61
    v_lshlrev_b32 v180, 16, v62
    v_and_b32 v181, 0xffff0000, v62
    v_lshlrev_b32 v182, 16, v63
    v_and_b32 v183, 0xffff0000, v63
    v_lshlrev_b32 v184, 16, v64
    v_and_b32 v185, 0xffff0000, v64
    v_lshlrev_b32 v186, 16, v65
    v_and_b32 v187, 0xffff0000, v65
    v_lshlrev_b32 v188, 16, v66
    v_and_b32 v189, 0xffff0000, v66
    v_lshlrev_b32 v190, 16, v67
    v_and_b32 v191, 0xffff0000, v67
    v_lshlrev_b32 v192, 16, v68
    v_and_b32 v193, 0xffff0000, v68
    v_lshlrev_b32 v194, 16, v69
    v_and_b32 v195, 0xffff0000, v69
    v_lshlrev_b32 v196, 16, v70
    v_and_b32 v197, 0xffff0000, v70
    v_lshlrev_b32 v198, 16, v71
    v_and_b32 v199, 0xffff0000, v71
    v_add_f32_dpp v16, v16, v16 quad_perm:[1,0,3,2] row_mask:0xf bank_mask:0xf
    v_add_f32_dpp v17, v17, v17 quad_perm:[1,0,3,2] row_mask:0xf bank_mask:0xf
    v_add_f32_dpp v18, v18, v18 quad_perm:[1,0,3,2] row_mask:0xf bank_mask:0xf
    v_add_f32_dpp v19, v19, v19 quad_perm:[1,0,3,2] row_mask:0xf bank_mask:0xf
    v_add_f32_dpp v16, v16, v16 quad_perm:[2,3,0,1] row_mask:0xf bank_mask:0xf
    v_add_f32_dpp v17, v17, v17 quad_perm:[2,3,0,1] row_mask:0xf bank_mask:0xf
    v_add_f32_dpp v18, v18, v18 quad_perm:[2,3,0,1] row_mask:0xf bank_mask:0xf
    v_add_f32_dpp v19, v19, v19 quad_perm:[2,3,0,1] row_mask:0xf bank_mask:0xf
    v_add_f32_dpp v16, v16, v16 row_half_mirror row_mask:0xf bank_mask:0xf
    v_add_f32_dpp v17, v17, v17 row_half_mirror row_mask:0xf bank_mask:0xf
    v_add_f32_dpp v18, v18, v18 row_half_mirror row_mask:0xf bank_mask:0xf
    v_add_f32_dpp v19, v19, v19 row_half_mirror row_mask:0xf bank_mask:0xf
    v_add_f32_dpp v16, v16, v16 row_mirror row_mask:0xf bank_mask:0xf
    v_add_f32_dpp v17, v17, v17 row_mirror row_mask:0xf bank_mask:0xf
    v_add_f32_dpp v18, v18, v18 row_mirror row_mask:0xf bank_mask:0xf
    v_add_f32_dpp v19, v19, v19 row_mirror row_mask:0xf bank_mask:0xf
    v_mov_b32 v32, v16
    v_mov_b32 v33, v17
    v_mov_b32 v34, v18
    v_mov_b32 v35, v19
    v_permlane16_swap_b32 v16, v32
    v_permlane16_swap_b32 v17, v33
    v_permlane16_swap_b32 v18, v34
    v_permlane16_swap_b32 v19, v35
    v_add_f32 v16, v16, v32
    v_add_f32 v17, v17, v33
    v_add_f32 v18, v18, v34
    v_add_f32 v19, v19, v35
    v_mul_f32 v16, 991054117, v16
    v_mov_b32 v24, 0
    v_mul_f32 v17, 991054117, v17
    v_mov_b32 v25, 0
    v_mul_f32 v18, 991054117, v18
    v_mov_b32 v26, 0
    v_mul_f32 v19, 991054117, v19
    v_mov_b32 v27, 0
    s_mov_b64 exec, s[6:7]
    v_sub_f32 v136, v136, v16
    v_sub_f32 v152, v152, v17
    v_sub_f32 v168, v168, v18
    v_sub_f32 v184, v184, v19
    v_fmac_f32 v24, v136, v136
    v_fmac_f32 v25, v152, v152
    v_fmac_f32 v26, v168, v168
    v_fmac_f32 v27, v184, v184
    v_sub_f32 v137, v137, v16
    v_sub_f32 v153, v153, v17
    v_sub_f32 v169, v169, v18
    v_sub_f32 v185, v185, v19
    v_fmac_f32 v24, v137, v137
    v_fmac_f32 v25, v153, v153
    v_fmac_f32 v26, v169, v169
    v_fmac_f32 v27, v185, v185
    v_sub_f32 v138, v138, v16
    v_sub_f32 v154, v154, v17
    v_sub_f32 v170, v170, v18
    v_sub_f32 v186, v186, v19
    v_fmac_f32 v24, v138, v138
    v_fmac_f32 v25, v154, v154
    v_fmac_f32 v26, v170, v170
    v_fmac_f32 v27, v186, v186
    v_sub_f32 v139, v139, v16
    v_sub_f32 v155, v155, v17
    v_sub_f32 v171, v171, v18
    v_sub_f32 v187, v187, v19
    v_fmac_f32 v24, v139, v139
    v_fmac_f32 v25, v155, v155
    v_fmac_f32 v26, v171, v171
    v_fmac_f32 v27, v187, v187
    v_sub_f32 v140, v140, v16
    v_sub_f32 v156, v156, v17
    v_sub_f32 v172, v172, v18
    v_sub_f32 v188, v188, v19
    v_fmac_f32 v24, v140, v140
    v_fmac_f32 v25, v156, v156
    v_fmac_f32 v26, v172, v172
    v_fmac_f32 v27, v188, v188
    v_sub_f32 v141, v141, v16
    v_sub_f32 v157, v157, v17
    v_sub_f32 v173, v173, v18
    v_sub_f32 v189, v189, v19
    v_fmac_f32 v24, v141, v141
    v_fmac_f32 v25, v157, v157
    v_fmac_f32 v26, v173, v173
    v_fmac_f32 v27, v189, v189
    v_sub_f32 v142, v142, v16
    v_sub_f32 v158, v158, v17
    v_sub_f32 v174, v174, v18
    v_sub_f32 v190, v190, v19
    v_fmac_f32 v24, v142, v142
    v_fmac_f32 v25, v158, v158
    v_fmac_f32 v26, v174, v174
    v_fmac_f32 v27, v190, v190
    v_sub_f32 v143, v143, v16
    v_sub_f32 v159, v159, v17
    v_sub_f32 v175, v175, v18
    v_sub_f32 v191, v191, v19
    v_fmac_f32 v24, v143, v143
    v_fmac_f32 v25, v159, v159
    v_fmac_f32 v26, v175, v175
    v_fmac_f32 v27, v191, v191
    v_sub_f32 v144, v144, v16
    v_sub_f32 v160, v160, v17
    v_sub_f32 v176, v176, v18
    v_sub_f32 v192, v192, v19
    v_fmac_f32 v24, v144, v144
    v_fmac_f32 v25, v160, v160
    v_fmac_f32 v26, v176, v176
    v_fmac_f32 v27, v192, v192
    v_sub_f32 v145, v145, v16
    v_sub_f32 v161, v161, v17
    v_sub_f32 v177, v177, v18
    v_sub_f32 v193, v193, v19
    v_fmac_f32 v24, v145, v145
    v_fmac_f32 v25, v161, v161
    v_fmac_f32 v26, v177, v177
    v_fmac_f32 v27, v193, v193
    v_sub_f32 v146, v146, v16
    v_sub_f32 v162, v162, v17
    v_sub_f32 v178, v178, v18
    v_sub_f32 v194, v194, v19
    v_fmac_f32 v24, v146, v146
    v_fmac_f32 v25, v162, v162
    v_fmac_f32 v26, v178, v178
    v_fmac_f32 v27, v194, v194
    v_sub_f32 v147, v147, v16
    v_sub_f32 v163, v163, v17
    v_sub_f32 v179, v179, v18
    v_sub_f32 v195, v195, v19
    v_fmac_f32 v24, v147, v147
    v_fmac_f32 v25, v163, v163
    v_fmac_f32 v26, v179, v179
    v_fmac_f32 v27, v195, v195
    v_sub_f32 v148, v148, v16
    v_sub_f32 v164, v164, v17
    v_sub_f32 v180, v180, v18
    v_sub_f32 v196, v196, v19
    v_fmac_f32 v24, v148, v148
    v_fmac_f32 v25, v164, v164
    v_fmac_f32 v26, v180, v180
    v_fmac_f32 v27, v196, v196
    v_sub_f32 v149, v149, v16
    v_sub_f32 v165, v165, v17
    v_sub_f32 v181, v181, v18
    v_sub_f32 v197, v197, v19
    v_fmac_f32 v24, v149, v149
    v_fmac_f32 v25, v165, v165
    v_fmac_f32 v26, v181, v181
    v_fmac_f32 v27, v197, v197
    v_sub_f32 v150, v150, v16
    v_sub_f32 v166, v166, v17
    v_sub_f32 v182, v182, v18
    v_sub_f32 v198, v198, v19
    v_fmac_f32 v24, v150, v150
    v_fmac_f32 v25, v166, v166
    v_fmac_f32 v26, v182, v182
    v_fmac_f32 v27, v198, v198
    v_sub_f32 v151, v151, v16
    v_sub_f32 v167, v167, v17
    v_sub_f32 v183, v183, v18
    v_sub_f32 v199, v199, v19
    v_fmac_f32 v24, v151, v151
    v_fmac_f32 v25, v167, v167
    v_fmac_f32 v26, v183, v183
    v_fmac_f32 v27, v199, v199
    s_mov_b64 exec, -1
    s_nop 4
    v_add_f32_dpp v24, v24, v24 quad_perm:[1,0,3,2] row_mask:0xf bank_mask:0xf
    v_add_f32_dpp v25, v25, v25 quad_perm:[1,0,3,2] row_mask:0xf bank_mask:0xf
    v_add_f32_dpp v26, v26, v26 quad_perm:[1,0,3,2] row_mask:0xf bank_mask:0xf
    v_add_f32_dpp v27, v27, v27 quad_perm:[1,0,3,2] row_mask:0xf bank_mask:0xf
    v_add_f32_dpp v24, v24, v24 quad_perm:[2,3,0,1] row_mask:0xf bank_mask:0xf
    v_add_f32_dpp v25, v25, v25 quad_perm:[2,3,0,1] row_mask:0xf bank_mask:0xf
    v_add_f32_dpp v26, v26, v26 quad_perm:[2,3,0,1] row_mask:0xf bank_mask:0xf
    v_add_f32_dpp v27, v27, v27 quad_perm:[2,3,0,1] row_mask:0xf bank_mask:0xf
    v_add_f32_dpp v24, v24, v24 row_half_mirror row_mask:0xf bank_mask:0xf
    v_add_f32_dpp v25, v25, v25 row_half_mirror row_mask:0xf bank_mask:0xf
    v_add_f32_dpp v26, v26, v26 row_half_mirror row_mask:0xf bank_mask:0xf
    v_add_f32_dpp v27, v27, v27 row_half_mirror row_mask:0xf bank_mask:0xf
    v_add_f32_dpp v24, v24, v24 row_mirror row_mask:0xf bank_mask:0xf
    v_add_f32_dpp v25, v25, v25 row_mirror row_mask:0xf bank_mask:0xf
    v_add_f32_dpp v26, v26, v26 row_mirror row_mask:0xf bank_mask:0xf
    v_add_f32_dpp v27, v27, v27 row_mirror row_mask:0xf bank_mask:0xf
    v_mov_b32 v32, v24
    v_mov_b32 v33, v25
    v_mov_b32 v34, v26
    v_mov_b32 v35, v27
    v_permlane16_swap_b32 v24, v32
    v_permlane16_swap_b32 v25, v33
    v_permlane16_swap_b32 v26, v34
    v_permlane16_swap_b32 v27, v35
    v_add_f32 v24, v24, v32
    v_add_f32 v25, v25, v33
    v_add_f32 v26, v26, v34
    v_add_f32 v27, v27, v35
    s_waitcnt vmcnt(8)
    v_mov_b32 v20, 0
    v_mov_b32 v21, 0
    v_mov_b32 v22, 0
    v_mov_b32 v23, 0
    v_dot2c_f32_bf16 v20, s70, v72
    v_dot2c_f32_bf16 v21, s70, v80
    v_dot2c_f32_bf16 v22, s70, v88
    v_dot2c_f32_bf16 v23, s70, v96
    v_dot2c_f32_bf16 v20, s70, v73
    v_dot2c_f32_bf16 v21, s70, v81
    v_dot2c_f32_bf16 v22, s70, v89
    v_dot2c_f32_bf16 v23, s70, v97
    v_dot2c_f32_bf16 v20, s70, v74
    v_dot2c_f32_bf16 v21, s70, v82
    v_dot2c_f32_bf16 v22, s70, v90
    v_dot2c_f32_bf16 v23, s70, v98
    v_dot2c_f32_bf16 v20, s70, v75
    v_dot2c_f32_bf16 v21, s70, v83
    v_dot2c_f32_bf16 v22, s70, v91
    v_dot2c_f32_bf16 v23, s70, v99
    v_dot2c_f32_bf16 v20, s70, v76
    v_dot2c_f32_bf16 v21, s70, v84
    v_dot2c_f32_bf16 v22, s70, v92
    v_dot2c_f32_bf16 v23, s70, v100
    v_dot2c_f32_bf16 v20, s70, v77
    v_dot2c_f32_bf16 v21, s70, v85
    v_dot2c_f32_bf16 v22, s70, v93
    v_dot2c_f32_bf16 v23, s70, v101
    v_dot2c_f32_bf16 v20, s70, v78
    v_dot2c_f32_bf16 v21, s70, v86
    v_dot2c_f32_bf16 v22, s70, v94
    v_dot2c_f32_bf16 v23, s70, v102
    v_dot2c_f32_bf16 v20, s70, v79
    v_dot2c_f32_bf16 v21, s70, v87
    v_dot2c_f32_bf16 v22, s70, v95
    v_dot2c_f32_bf16 v23, s70, v103
    v_lshlrev_b32 v136, 16, v72
    v_and_b32 v137, 0xffff0000, v72
    v_lshlrev_b32 v138, 16, v73
    v_and_b32 v139, 0xffff0000, v73
    v_lshlrev_b32 v140, 16, v74
    v_and_b32 v141, 0xffff0000, v74
    v_lshlrev_b32 v142, 16, v75
    v_and_b32 v143, 0xffff0000, v75
    v_lshlrev_b32 v144, 16, v76
    v_and_b32 v145, 0xffff0000, v76
    v_lshlrev_b32 v146, 16, v77
    v_and_b32 v147, 0xffff0000, v77
    v_lshlrev_b32 v148, 16, v78
    v_and_b32 v149, 0xffff0000, v78
    v_lshlrev_b32 v150, 16, v79
    v_and_b32 v151, 0xffff0000, v79
    v_lshlrev_b32 v152, 16, v80
    v_and_b32 v153, 0xffff0000, v80
    v_lshlrev_b32 v154, 16, v81
    v_and_b32 v155, 0xffff0000, v81
    v_lshlrev_b32 v156, 16, v82
    v_and_b32 v157, 0xffff0000, v82
    v_lshlrev_b32 v158, 16, v83
    v_and_b32 v159, 0xffff0000, v83
    v_lshlrev_b32 v160, 16, v84
    v_and_b32 v161, 0xffff0000, v84
    v_lshlrev_b32 v162, 16, v85
    v_and_b32 v163, 0xffff0000, v85
    v_lshlrev_b32 v164, 16, v86
    v_and_b32 v165, 0xffff0000, v86
    v_lshlrev_b32 v166, 16, v87
    v_and_b32 v167, 0xffff0000, v87
    v_lshlrev_b32 v168, 16, v88
    v_and_b32 v169, 0xffff0000, v88
    v_lshlrev_b32 v170, 16, v89
    v_and_b32 v171, 0xffff0000, v89
    v_lshlrev_b32 v172, 16, v90
    v_and_b32 v173, 0xffff0000, v90
    v_lshlrev_b32 v174, 16, v91
    v_and_b32 v175, 0xffff0000, v91
    v_lshlrev_b32 v176, 16, v92
    v_and_b32 v177, 0xffff0000, v92
    v_lshlrev_b32 v178, 16, v93
    v_and_b32 v179, 0xffff0000, v93
    v_lshlrev_b32 v180, 16, v94
    v_and_b32 v181, 0xffff0000, v94
    v_lshlrev_b32 v182, 16, v95
    v_and_b32 v183, 0xffff0000, v95
    v_lshlrev_b32 v184, 16, v96
    v_and_b32 v185, 0xffff0000, v96
    v_lshlrev_b32 v186, 16, v97
    v_and_b32 v187, 0xffff0000, v97
    v_lshlrev_b32 v188, 16, v98
    v_and_b32 v189, 0xffff0000, v98
    v_lshlrev_b32 v190, 16, v99
    v_and_b32 v191, 0xffff0000, v99
    v_lshlrev_b32 v192, 16, v100
    v_and_b32 v193, 0xffff0000, v100
    v_lshlrev_b32 v194, 16, v101
    v_and_b32 v195, 0xffff0000, v101
    v_lshlrev_b32 v196, 16, v102
    v_and_b32 v197, 0xffff0000, v102
    v_lshlrev_b32 v198, 16, v103
    v_and_b32 v199, 0xffff0000, v103
    v_add_f32_dpp v20, v20, v20 quad_perm:[1,0,3,2] row_mask:0xf bank_mask:0xf
    v_add_f32_dpp v21, v21, v21 quad_perm:[1,0,3,2] row_mask:0xf bank_mask:0xf
    v_add_f32_dpp v22, v22, v22 quad_perm:[1,0,3,2] row_mask:0xf bank_mask:0xf
    v_add_f32_dpp v23, v23, v23 quad_perm:[1,0,3,2] row_mask:0xf bank_mask:0xf
    v_add_f32_dpp v20, v20, v20 quad_perm:[2,3,0,1] row_mask:0xf bank_mask:0xf
    v_add_f32_dpp v21, v21, v21 quad_perm:[2,3,0,1] row_mask:0xf bank_mask:0xf
    v_add_f32_dpp v22, v22, v22 quad_perm:[2,3,0,1] row_mask:0xf bank_mask:0xf
    v_add_f32_dpp v23, v23, v23 quad_perm:[2,3,0,1] row_mask:0xf bank_mask:0xf
    v_add_f32_dpp v20, v20, v20 row_half_mirror row_mask:0xf bank_mask:0xf
    v_add_f32_dpp v21, v21, v21 row_half_mirror row_mask:0xf bank_mask:0xf
    v_add_f32_dpp v22, v22, v22 row_half_mirror row_mask:0xf bank_mask:0xf
    v_add_f32_dpp v23, v23, v23 row_half_mirror row_mask:0xf bank_mask:0xf
    v_add_f32_dpp v20, v20, v20 row_mirror row_mask:0xf bank_mask:0xf
    v_add_f32_dpp v21, v21, v21 row_mirror row_mask:0xf bank_mask:0xf
    v_add_f32_dpp v22, v22, v22 row_mirror row_mask:0xf bank_mask:0xf
    v_add_f32_dpp v23, v23, v23 row_mirror row_mask:0xf bank_mask:0xf
    v_mov_b32 v36, v20
    v_mov_b32 v37, v21
    v_mov_b32 v38, v22
    v_mov_b32 v39, v23
    v_permlane16_swap_b32 v20, v36
    v_permlane16_swap_b32 v21, v37
    v_permlane16_swap_b32 v22, v38
    v_permlane16_swap_b32 v23, v39
    v_add_f32 v20, v20, v36
    v_add_f32 v21, v21, v37
    v_add_f32 v22, v22, v38
    v_add_f32 v23, v23, v39
    v_mul_f32 v20, 991054117, v20
    v_mov_b32 v28, 0
    v_mul_f32 v21, 991054117, v21
    v_mov_b32 v29, 0
    v_mul_f32 v22, 991054117, v22
    v_mov_b32 v30, 0
    v_mul_f32 v23, 991054117, v23
    v_mov_b32 v31, 0
    s_mov_b64 exec, s[6:7]
    v_sub_f32 v136, v136, v20
    v_sub_f32 v152, v152, v21
    v_sub_f32 v168, v168, v22
    v_sub_f32 v184, v184, v23
    v_fmac_f32 v28, v136, v136
    v_fmac_f32 v29, v152, v152
    v_fmac_f32 v30, v168, v168
    v_fmac_f32 v31, v184, v184
    v_sub_f32 v137, v137, v20
    v_sub_f32 v153, v153, v21
    v_sub_f32 v169, v169, v22
    v_sub_f32 v185, v185, v23
    v_fmac_f32 v28, v137, v137
    v_fmac_f32 v29, v153, v153
    v_fmac_f32 v30, v169, v169
    v_fmac_f32 v31, v185, v185
    v_sub_f32 v138, v138, v20
    v_sub_f32 v154, v154, v21
    v_sub_f32 v170, v170, v22
    v_sub_f32 v186, v186, v23
    v_fmac_f32 v28, v138, v138
    v_fmac_f32 v29, v154, v154
    v_fmac_f32 v30, v170, v170
    v_fmac_f32 v31, v186, v186
    v_sub_f32 v139, v139, v20
    v_sub_f32 v155, v155, v21
    v_sub_f32 v171, v171, v22
    v_sub_f32 v187, v187, v23
    v_fmac_f32 v28, v139, v139
    v_fmac_f32 v29, v155, v155
    v_fmac_f32 v30, v171, v171
    v_fmac_f32 v31, v187, v187
    v_sub_f32 v140, v140, v20
    v_sub_f32 v156, v156, v21
    v_sub_f32 v172, v172, v22
    v_sub_f32 v188, v188, v23
    v_fmac_f32 v28, v140, v140
    v_fmac_f32 v29, v156, v156
    v_fmac_f32 v30, v172, v172
    v_fmac_f32 v31, v188, v188
    v_sub_f32 v141, v141, v20
    v_sub_f32 v157, v157, v21
    v_sub_f32 v173, v173, v22
    v_sub_f32 v189, v189, v23
    v_fmac_f32 v28, v141, v141
    v_fmac_f32 v29, v157, v157
    v_fmac_f32 v30, v173, v173
    v_fmac_f32 v31, v189, v189
    v_sub_f32 v142, v142, v20
    v_sub_f32 v158, v158, v21
    v_sub_f32 v174, v174, v22
    v_sub_f32 v190, v190, v23
    v_fmac_f32 v28, v142, v142
    v_fmac_f32 v29, v158, v158
    v_fmac_f32 v30, v174, v174
    v_fmac_f32 v31, v190, v190
    v_sub_f32 v143, v143, v20
    v_sub_f32 v159, v159, v21
    v_sub_f32 v175, v175, v22
    v_sub_f32 v191, v191, v23
    v_fmac_f32 v28, v143, v143
    v_fmac_f32 v29, v159, v159
    v_fmac_f32 v30, v175, v175
    v_fmac_f32 v31, v191, v191
    v_sub_f32 v144, v144, v20
    v_sub_f32 v160, v160, v21
    v_sub_f32 v176, v176, v22
    v_sub_f32 v192, v192, v23
    v_fmac_f32 v28, v144, v144
    v_fmac_f32 v29, v160, v160
    v_fmac_f32 v30, v176, v176
    v_fmac_f32 v31, v192, v192
    v_sub_f32 v145, v145, v20
    v_sub_f32 v161, v161, v21
    v_sub_f32 v177, v177, v22
    v_sub_f32 v193, v193, v23
    v_fmac_f32 v28, v145, v145
    v_fmac_f32 v29, v161, v161
    v_fmac_f32 v30, v177, v177
    v_fmac_f32 v31, v193, v193
    v_sub_f32 v146, v146, v20
    v_sub_f32 v162, v162, v21
    v_sub_f32 v178, v178, v22
    v_sub_f32 v194, v194, v23
    v_fmac_f32 v28, v146, v146
    v_fmac_f32 v29, v162, v162
    v_fmac_f32 v30, v178, v178
    v_fmac_f32 v31, v194, v194
    v_sub_f32 v147, v147, v20
    v_sub_f32 v163, v163, v21
    v_sub_f32 v179, v179, v22
    v_sub_f32 v195, v195, v23
    v_fmac_f32 v28, v147, v147
    v_fmac_f32 v29, v163, v163
    v_fmac_f32 v30, v179, v179
    v_fmac_f32 v31, v195, v195
    v_sub_f32 v148, v148, v20
    v_sub_f32 v164, v164, v21
    v_sub_f32 v180, v180, v22
    v_sub_f32 v196, v196, v23
    v_fmac_f32 v28, v148, v148
    v_fmac_f32 v29, v164, v164
    v_fmac_f32 v30, v180, v180
    v_fmac_f32 v31, v196, v196
    v_sub_f32 v149, v149, v20
    v_sub_f32 v165, v165, v21
    v_sub_f32 v181, v181, v22
    v_sub_f32 v197, v197, v23
    v_fmac_f32 v28, v149, v149
    v_fmac_f32 v29, v165, v165
    v_fmac_f32 v30, v181, v181
    v_fmac_f32 v31, v197, v197
    v_sub_f32 v150, v150, v20
    v_sub_f32 v166, v166, v21
    v_sub_f32 v182, v182, v22
    v_sub_f32 v198, v198, v23
    v_fmac_f32 v28, v150, v150
    v_fmac_f32 v29, v166, v166
    v_fmac_f32 v30, v182, v182
    v_fmac_f32 v31, v198, v198
    v_sub_f32 v151, v151, v20
    v_sub_f32 v167, v167, v21
    v_sub_f32 v183, v183, v22
    v_sub_f32 v199, v199, v23
    v_fmac_f32 v28, v151, v151
    v_fmac_f32 v29, v167, v167
    v_fmac_f32 v30, v183, v183
    v_fmac_f32 v31, v199, v199
    s_mov_b64 exec, -1
    s_nop 4
    v_add_f32_dpp v28, v28, v28 quad_perm:[1,0,3,2] row_mask:0xf bank_mask:0xf
    v_add_f32_dpp v29, v29, v29 quad_perm:[1,0,3,2] row_mask:0xf bank_mask:0xf
    v_add_f32_dpp v30, v30, v30 quad_perm:[1,0,3,2] row_mask:0xf bank_mask:0xf
    v_add_f32_dpp v31, v31, v31 quad_perm:[1,0,3,2] row_mask:0xf bank_mask:0xf
    v_add_f32_dpp v28, v28, v28 quad_perm:[2,3,0,1] row_mask:0xf bank_mask:0xf
    v_add_f32_dpp v29, v29, v29 quad_perm:[2,3,0,1] row_mask:0xf bank_mask:0xf
    v_add_f32_dpp v30, v30, v30 quad_perm:[2,3,0,1] row_mask:0xf bank_mask:0xf
    v_add_f32_dpp v31, v31, v31 quad_perm:[2,3,0,1] row_mask:0xf bank_mask:0xf
    v_add_f32_dpp v28, v28, v28 row_half_mirror row_mask:0xf bank_mask:0xf
    v_add_f32_dpp v29, v29, v29 row_half_mirror row_mask:0xf bank_mask:0xf
    v_add_f32_dpp v30, v30, v30 row_half_mirror row_mask:0xf bank_mask:0xf
    v_add_f32_dpp v31, v31, v31 row_half_mirror row_mask:0xf bank_mask:0xf
    v_add_f32_dpp v28, v28, v28 row_mirror row_mask:0xf bank_mask:0xf
    v_add_f32_dpp v29, v29, v29 row_mirror row_mask:0xf bank_mask:0xf
    v_add_f32_dpp v30, v30, v30 row_mirror row_mask:0xf bank_mask:0xf
    v_add_f32_dpp v31, v31, v31 row_mirror row_mask:0xf bank_mask:0xf
    v_mov_b32 v36, v28
    v_mov_b32 v37, v29
    v_mov_b32 v38, v30
    v_mov_b32 v39, v31
    v_permlane16_swap_b32 v28, v36
    v_permlane16_swap_b32 v29, v37
    v_permlane16_swap_b32 v30, v38
    v_permlane16_swap_b32 v31, v39
    v_add_f32 v28, v28, v36
    v_add_f32 v29, v29, v37
    v_add_f32 v30, v30, v38
    v_add_f32 v31, v31, v39
    s_waitcnt vmcnt(0)
    v_mov_b32 v200, 0
    v_mov_b32 v201, 0
    v_mov_b32 v202, 0
    v_mov_b32 v203, 0
    v_dot2c_f32_bf16 v200, s70, v104
    v_dot2c_f32_bf16 v201, s70, v112
    v_dot2c_f32_bf16 v202, s70, v120
    v_dot2c_f32_bf16 v203, s70, v128
    v_dot2c_f32_bf16 v200, s70, v105
    v_dot2c_f32_bf16 v201, s70, v113
    v_dot2c_f32_bf16 v202, s70, v121
    v_dot2c_f32_bf16 v203, s70, v129
    v_dot2c_f32_bf16 v200, s70, v106
    v_dot2c_f32_bf16 v201, s70, v114
    v_dot2c_f32_bf16 v202, s70, v122
    v_dot2c_f32_bf16 v203, s70, v130
    v_dot2c_f32_bf16 v200, s70, v107
    v_dot2c_f32_bf16 v201, s70, v115
    v_dot2c_f32_bf16 v202, s70, v123
    v_dot2c_f32_bf16 v203, s70, v131
    v_dot2c_f32_bf16 v200, s70, v108
    v_dot2c_f32_bf16 v201, s70, v116
    v_dot2c_f32_bf16 v202, s70, v124
    v_dot2c_f32_bf16 v203, s70, v132
    v_dot2c_f32_bf16 v200, s70, v109
    v_dot2c_f32_bf16 v201, s70, v117
    v_dot2c_f32_bf16 v202, s70, v125
    v_dot2c_f32_bf16 v203, s70, v133
    v_dot2c_f32_bf16 v200, s70, v110
    v_dot2c_f32_bf16 v201, s70, v118
    v_dot2c_f32_bf16 v202, s70, v126
    v_dot2c_f32_bf16 v203, s70, v134
    v_dot2c_f32_bf16 v200, s70, v111
    v_dot2c_f32_bf16 v201, s70, v119
    v_dot2c_f32_bf16 v202, s70, v127
    v_dot2c_f32_bf16 v203, s70, v135
    s_nop 3
    v_add_f32_dpp v200, v200, v200 quad_perm:[1,0,3,2] row_mask:0xf bank_mask:0xf
    v_add_f32_dpp v201, v201, v201 quad_perm:[1,0,3,2] row_mask:0xf bank_mask:0xf
    v_add_f32_dpp v202, v202, v202 quad_perm:[1,0,3,2] row_mask:0xf bank_mask:0xf
    v_add_f32_dpp v203, v203, v203 quad_perm:[1,0,3,2] row_mask:0xf bank_mask:0xf
    v_add_f32_dpp v200, v200, v200 quad_perm:[2,3,0,1] row_mask:0xf bank_mask:0xf
    v_add_f32_dpp v201, v201, v201 quad_perm:[2,3,0,1] row_mask:0xf bank_mask:0xf
    v_add_f32_dpp v202, v202, v202 quad_perm:[2,3,0,1] row_mask:0xf bank_mask:0xf
    v_add_f32_dpp v203, v203, v203 quad_perm:[2,3,0,1] row_mask:0xf bank_mask:0xf
    v_add_f32_dpp v200, v200, v200 row_half_mirror row_mask:0xf bank_mask:0xf
    v_add_f32_dpp v201, v201, v201 row_half_mirror row_mask:0xf bank_mask:0xf
    v_add_f32_dpp v202, v202, v202 row_half_mirror row_mask:0xf bank_mask:0xf
    v_add_f32_dpp v203, v203, v203 row_half_mirror row_mask:0xf bank_mask:0xf
    v_add_f32_dpp v200, v200, v200 row_mirror row_mask:0xf bank_mask:0xf
    v_add_f32_dpp v201, v201, v201 row_mirror row_mask:0xf bank_mask:0xf
    v_add_f32_dpp v202, v202, v202 row_mirror row_mask:0xf bank_mask:0xf
    v_add_f32_dpp v203, v203, v203 row_mirror row_mask:0xf bank_mask:0xf
    v_mov_b32 v204, v200
    v_mov_b32 v205, v201
    v_mov_b32 v206, v202
    v_mov_b32 v207, v203
    v_permlane16_swap_b32 v200, v204
    v_permlane16_swap_b32 v201, v205
    v_permlane16_swap_b32 v202, v206
    v_permlane16_swap_b32 v203, v207
    v_add_f32 v200, v200, v204
    v_add_f32 v201, v201, v205
    v_add_f32 v202, v202, v206
    v_add_f32 v203, v203, v207
    v_cmp_eq_u32 vcc, 1, v3
    s_nop 0
    s_nop 0
    v_cndmask_b32 v16, v16, v17, vcc
    v_cndmask_b32 v24, v24, v25, vcc
    v_cndmask_b32 v200, v200, v201, vcc
    v_cmp_eq_u32 vcc, 2, v3
    s_nop 0
    s_nop 0
    v_cndmask_b32 v16, v16, v18, vcc
    v_cndmask_b32 v24, v24, v26, vcc
    v_cndmask_b32 v200, v200, v202, vcc
    v_cmp_eq_u32 vcc, 3, v3
    s_nop 0
    s_nop 0
    v_cndmask_b32 v16, v16, v19, vcc
    v_cndmask_b32 v24, v24, v27, vcc
    v_cndmask_b32 v200, v200, v203, vcc
    v_cmp_eq_u32 vcc, 4, v3
    s_nop 0
    s_nop 0
    v_cndmask_b32 v16, v16, v20, vcc
    v_cndmask_b32 v24, v24, v28, vcc
    v_cmp_eq_u32 vcc, 5, v3
    s_nop 0
    s_nop 0
    v_cndmask_b32 v16, v16, v21, vcc
    v_cndmask_b32 v24, v24, v29, vcc
    v_cmp_eq_u32 vcc, 6, v3
    s_nop 0
    s_nop 0
    v_cndmask_b32 v16, v16, v22, vcc
    v_cndmask_b32 v24, v24, v30, vcc
    v_cmp_eq_u32 vcc, 7, v3
    s_nop 0
    s_nop 0
    v_cndmask_b32 v16, v16, v23, vcc
    v_cndmask_b32 v24, v24, v31, vcc
    v_mul_f32 v24, 991054117, v24
    v_cvt_pk_bf16_f32 v16, 0, v16
    v_cvt_pk_bf16_f32 v24, 0, v24
    v_add_f32 v24, 0x3727c5ac, v24
    v_cvt_pk_bf16_f32 v24, 0, v24
    v_sqrt_f32 v24, v24
    s_nop 0
    v_cvt_pk_bf16_f32 v24, 0, v24
    v_rcp_f32 v32, v24
    v_lshl_add_u32 v207, v3, 1, v9
    v_and_b32 v208, 31, v207
    v_and_b32 v209, 3, v208
    v_bfe_u32 v210, v208, 2, 2
    v_lshl_or_b32 v209, v210, 3, v209
    v_bfe_u32 v210, v208, 4, 1
    v_lshl_or_b32 v209, v210, 2, v209
    v_and_b32 v207, 0xffffffe0, v207
    v_or_b32 v207, v207, v209
    v_lshlrev_b32 v207, 2, v207
    v_lshl_add_u32 v208, v3, 1, v11
    v_lshlrev_b32 v208, 2, v208
    s_mov_b32 s4, 0xff
    s_mov_b32 s5, 0xff
    s_mov_b64 exec, s[4:5]
    s_mov_b32 s3, 14942208
    buffer_store_dword v16, v207, s[60:63], s3 offen sc0 sc1
    s_mov_b32 s3, 14950400
    buffer_store_dword v32, v207, s[60:63], s3 offen sc0 sc1
    s_mov_b32 s3, 14958592
    buffer_store_dword v24, v207, s[60:63], s3 offen sc0 sc1
    s_cmp_eq_u32 s66, 3
    s_cselect_b32 s4, 3, 15
    s_mov_b32 s5, s4
    s_mov_b64 exec, s[4:5]
    s_lshr_b32 s3, s64, 4
    s_mul_i32 s3, s3, 1792
    s_add_u32 s3, s3, 14989312
    buffer_store_dword v200, v208, s[60:63], s3 offen sc0 sc1
    s_mov_b64 exec, -1
    s_barrier
    s_branch L_SP6
L_SPW:
    v_mov_b32 v4, 0
    v_mov_b32 v5, 0
    v_mov_b32 v6, 0
    v_mov_b32 v7, 0
    v_subrev_u32 v8, 256, v0
    v_cmp_gt_u32 vcc, 232, v8
    s_nop 0
    s_and_saveexec_b64 s[4:5], vcc
    s_cbranch_execz L_SP1
    v_lshlrev_b32 v8, 4, v8
    s_mul_i32 s3, s64, 3712
    s_add_u32 s3, s3, 14680064
    buffer_store_dwordx4 v[4:7], v8, s[60:63], s3 offen sc0 sc1
L_SP1:
    s_mov_b64 exec, s[4:5]
    s_cmp_ge_u32 s64, 28
    s_cbranch_scc1 L_SPX
    s_cmp_lt_u32 s66, 6
    s_cselect_b32 s48, s36, s38
    s_cselect_b32 s49, s37, s39
    s_and_b32 s49, s49, 0xffff
    s_mov_b32 s50, 1605632
    s_mov_b32 s51, 0x20000
    v_lshrrev_b32 v10, 3, v1
    v_bfe_u32 v11, v1, 4, 1
    v_lshlrev_b32 v11, 2, v11
    v_and_b32 v12, 7, v1
    v_xor_b32 v11, v11, v12
    v_mul_u32_u24 v10, 3584, v10
    v_lshl_add_u32 v10, v11, 4, v10
    s_and_b32 s3, s64, 1
    s_mul_i32 s3, s3, 14
    s_lshr_b32 s68, s64, 1
    s_add_u32 s68, s68, s3
    s_and_b32 s67, s66, 1
    s_mul_i32 s3, s67, 802816
    s_lshl_b32 s4, s68, 7
    s_add_u32 s3, s3, s4
    v_add_u32 v10, s3, v10
    s_sub_u32 s90, s66, 4
    s_mul_i32 s90, s90, 28672
    s_add_u32 m0, s90, 0
    s_mov_b32 s3, 0
    buffer_load_dwordx4 v10, s[48:51], s3 offen lds
    s_add_u32 m0, s90, 1024
    s_mov_b32 s3, 28672
    buffer_load_dwordx4 v10, s[48:51], s3 offen lds
    s_add_u32 m0, s90, 2048
    s_mov_b32 s3, 57344
    buffer_load_dwordx4 v10, s[48:51], s3 offen lds
    s_add_u32 m0, s90, 3072
    s_mov_b32 s3, 86016
    buffer_load_dwordx4 v10, s[48:51], s3 offen lds
    s_add_u32 m0, s90, 4096
    s_mov_b32 s3, 114688
    buffer_load_dwordx4 v10, s[48:51], s3 offen lds
    s_add_u32 m0, s90, 5120
    s_mov_b32 s3, 143360
    buffer_load_dwordx4 v10, s[48:51], s3 offen lds
    s_add_u32 m0, s90, 6144
    s_mov_b32 s3, 172032
    buffer_load_dwordx4 v10, s[48:51], s3 offen lds
    s_add_u32 m0, s90, 7168
    s_mov_b32 s3, 200704
    buffer_load_dwordx4 v10, s[48:51], s3 offen lds
    s_add_u32 m0, s90, 8192
    s_mov_b32 s3, 229376
    buffer_load_dwordx4 v10, s[48:51], s3 offen lds
    s_add_u32 m0, s90, 9216
    s_mov_b32 s3, 258048
    buffer_load_dwordx4 v10, s[48:51], s3 offen lds
    s_add_u32 m0, s90, 10240
    s_mov_b32 s3, 286720
    buffer_load_dwordx4 v10, s[48:51], s3 offen lds
    s_add_u32 m0, s90, 11264
    s_mov_b32 s3, 315392
    buffer_load_dwordx4 v10, s[48:51], s3 offen lds
    s_add_u32 m0, s90, 12288
    s_mov_b32 s3, 344064
    buffer_load_dwordx4 v10, s[48:51], s3 offen lds
    s_add_u32 m0, s90, 13312
    s_mov_b32 s3, 372736
    buffer_load_dwordx4 v10, s[48:51], s3 offen lds
    s_add_u32 m0, s90, 14336
    s_mov_b32 s3, 401408
    buffer_load_dwordx4 v10, s[48:51], s3 offen lds
    s_add_u32 m0, s90, 15360
    s_mov_b32 s3, 430080
    buffer_load_dwordx4 v10, s[48:51], s3 offen lds
    s_add_u32 m0, s90, 16384
    s_mov_b32 s3, 458752
    buffer_load_dwordx4 v10, s[48:51], s3 offen lds
    s_add_u32 m0, s90, 17408
    s_mov_b32 s3, 487424
    buffer_load_dwordx4 v10, s[48:51], s3 offen lds
    s_add_u32 m0, s90, 18432
    s_mov_b32 s3, 516096
    buffer_load_dwordx4 v10, s[48:51], s3 offen lds
    s_add_u32 m0, s90, 19456
    s_mov_b32 s3, 544768
    buffer_load_dwordx4 v10, s[48:51], s3 offen lds
    s_add_u32 m0, s90, 20480
    s_mov_b32 s3, 573440
    buffer_load_dwordx4 v10, s[48:51], s3 offen lds
    s_add_u32 m0, s90, 21504
    s_mov_b32 s3, 602112
    buffer_load_dwordx4 v10, s[48:51], s3 offen lds
    s_add_u32 m0, s90, 22528
    s_mov_b32 s3, 630784
    buffer_load_dwordx4 v10, s[48:51], s3 offen lds
    s_add_u32 m0, s90, 23552
    s_mov_b32 s3, 659456
    buffer_load_dwordx4 v10, s[48:51], s3 offen lds
    s_add_u32 m0, s90, 24576
    s_mov_b32 s3, 688128
    buffer_load_dwordx4 v10, s[48:51], s3 offen lds
    s_add_u32 m0, s90, 25600
    s_mov_b32 s3, 716800
    buffer_load_dwordx4 v10, s[48:51], s3 offen lds
    s_add_u32 m0, s90, 26624
    s_mov_b32 s3, 745472
    buffer_load_dwordx4 v10, s[48:51], s3 offen lds
    s_add_u32 m0, s90, 27648
    s_mov_b32 s3, 774144
    buffer_load_dwordx4 v10, s[48:51], s3 offen lds
    v_bfe_u32 v12, v1, 2, 2
    v_lshrrev_b32 v11, 5, v1
    v_lshl_add_u32 v11, v11, 2, v12
    v_lshlrev_b32 v11, 7, v11
    v_bfe_u32 v12, v1, 3, 1
    v_lshl_add_u32 v11, v12, 6, v11
    v_bfe_u32 v12, v1, 4, 1
    v_lshl_add_u32 v11, v12, 5, v11
    v_and_b32 v12, 3, v1
    v_lshl_add_u32 v11, v12, 3, v11
    v_add_u32 v11, s90, v11
    v_xor_b32 v12, 64, v11
    v_mov_b32 v16, 0x3f803f80
    v_mov_b32 v17, 0x3f803f80
    v_mov_b32 v18, 0x3f803f80
    v_mov_b32 v19, 0x3f803f80
    s_waitcnt vmcnt(26)
    ds_read_b64_tr_b16 v[20:21], v11 offset:0
    ds_read_b64_tr_b16 v[22:23], v11 offset:1024
    ds_read_b64_tr_b16 v[24:25], v12 offset:0
    ds_read_b64_tr_b16 v[26:27], v12 offset:1024
    s_waitcnt lgkmcnt(0)
    v_mfma_f32_32x32x16_bf16 v[40:55], v[16:19], v[20:23], 0
    v_mfma_f32_32x32x16_bf16 v[56:71], v[16:19], v[24:27], 0
    s_waitcnt vmcnt(24)
    ds_read_b64_tr_b16 v[28:29], v11 offset:2048
    ds_read_b64_tr_b16 v[30:31], v11 offset:3072
    ds_read_b64_tr_b16 v[32:33], v12 offset:2048
    ds_read_b64_tr_b16 v[34:35], v12 offset:3072
    s_waitcnt lgkmcnt(0)
    v_mfma_f32_32x32x16_bf16 v[40:55], v[16:19], v[28:31], v[40:55]
    v_mfma_f32_32x32x16_bf16 v[56:71], v[16:19], v[32:35], v[56:71]
    s_waitcnt vmcnt(22)
    ds_read_b64_tr_b16 v[20:21], v11 offset:4096
    ds_read_b64_tr_b16 v[22:23], v11 offset:5120
    ds_read_b64_tr_b16 v[24:25], v12 offset:4096
    ds_read_b64_tr_b16 v[26:27], v12 offset:5120
    s_waitcnt lgkmcnt(0)
    v_mfma_f32_32x32x16_bf16 v[40:55], v[16:19], v[20:23], v[40:55]
    v_mfma_f32_32x32x16_bf16 v[56:71], v[16:19], v[24:27], v[56:71]
    s_waitcnt vmcnt(20)
    ds_read_b64_tr_b16 v[28:29], v11 offset:6144
    ds_read_b64_tr_b16 v[30:31], v11 offset:7168
    ds_read_b64_tr_b16 v[32:33], v12 offset:6144
    ds_read_b64_tr_b16 v[34:35], v12 offset:7168
    s_waitcnt lgkmcnt(0)
    v_mfma_f32_32x32x16_bf16 v[40:55], v[16:19], v[28:31], v[40:55]
    v_mfma_f32_32x32x16_bf16 v[56:71], v[16:19], v[32:35], v[56:71]
    s_waitcnt vmcnt(18)
    ds_read_b64_tr_b16 v[20:21], v11 offset:8192
    ds_read_b64_tr_b16 v[22:23], v11 offset:9216
    ds_read_b64_tr_b16 v[24:25], v12 offset:8192
    ds_read_b64_tr_b16 v[26:27], v12 offset:9216
    s_waitcnt lgkmcnt(0)
    v_mfma_f32_32x32x16_bf16 v[40:55], v[16:19], v[20:23], v[40:55]
    v_mfma_f32_32x32x16_bf16 v[56:71], v[16:19], v[24:27], v[56:71]
    s_waitcnt vmcnt(16)
    ds_read_b64_tr_b16 v[28:29], v11 offset:10240
    ds_read_b64_tr_b16 v[30:31], v11 offset:11264
    ds_read_b64_tr_b16 v[32:33], v12 offset:10240
    ds_read_b64_tr_b16 v[34:35], v12 offset:11264
    s_waitcnt lgkmcnt(0)
    v_mfma_f32_32x32x16_bf16 v[40:55], v[16:19], v[28:31], v[40:55]
    v_mfma_f32_32x32x16_bf16 v[56:71], v[16:19], v[32:35], v[56:71]
    s_waitcnt vmcnt(14)
    ds_read_b64_tr_b16 v[20:21], v11 offset:12288
    ds_read_b64_tr_b16 v[22:23], v11 offset:13312
    ds_read_b64_tr_b16 v[24:25], v12 offset:12288
    ds_read_b64_tr_b16 v[26:27], v12 offset:13312
    s_waitcnt lgkmcnt(0)
    v_mfma_f32_32x32x16_bf16 v[40:55], v[16:19], v[20:23], v[40:55]
    v_mfma_f32_32x32x16_bf16 v[56:71], v[16:19], v[24:27], v[56:71]
    s_waitcnt vmcnt(12)
    ds_read_b64_tr_b16 v[28:29], v11 offset:14336
    ds_read_b64_tr_b16 v[30:31], v11 offset:15360
    ds_read_b64_tr_b16 v[32:33], v12 offset:14336
    ds_read_b64_tr_b16 v[34:35], v12 offset:15360
    s_waitcnt lgkmcnt(0)
    v_mfma_f32_32x32x16_bf16 v[40:55], v[16:19], v[28:31], v[40:55]
    v_mfma_f32_32x32x16_bf16 v[56:71], v[16:19], v[32:35], v[56:71]
    s_waitcnt vmcnt(10)
    ds_read_b64_tr_b16 v[20:21], v11 offset:16384
    ds_read_b64_tr_b16 v[22:23], v11 offset:17408
    ds_read_b64_tr_b16 v[24:25], v12 offset:16384
    ds_read_b64_tr_b16 v[26:27], v12 offset:17408
    s_waitcnt lgkmcnt(0)
    v_mfma_f32_32x32x16_bf16 v[40:55], v[16:19], v[20:23], v[40:55]
    v_mfma_f32_32x32x16_bf16 v[56:71], v[16:19], v[24:27], v[56:71]
    s_waitcnt vmcnt(8)
    ds_read_b64_tr_b16 v[28:29], v11 offset:18432
    ds_read_b64_tr_b16 v[30:31], v11 offset:19456
    ds_read_b64_tr_b16 v[32:33], v12 offset:18432
    ds_read_b64_tr_b16 v[34:35], v12 offset:19456
    s_waitcnt lgkmcnt(0)
    v_mfma_f32_32x32x16_bf16 v[40:55], v[16:19], v[28:31], v[40:55]
    v_mfma_f32_32x32x16_bf16 v[56:71], v[16:19], v[32:35], v[56:71]
    s_waitcnt vmcnt(6)
    ds_read_b64_tr_b16 v[20:21], v11 offset:20480
    ds_read_b64_tr_b16 v[22:23], v11 offset:21504
    ds_read_b64_tr_b16 v[24:25], v12 offset:20480
    ds_read_b64_tr_b16 v[26:27], v12 offset:21504
    s_waitcnt lgkmcnt(0)
    v_mfma_f32_32x32x16_bf16 v[40:55], v[16:19], v[20:23], v[40:55]
    v_mfma_f32_32x32x16_bf16 v[56:71], v[16:19], v[24:27], v[56:71]
    s_waitcnt vmcnt(4)
    ds_read_b64_tr_b16 v[28:29], v11 offset:22528
    ds_read_b64_tr_b16 v[30:31], v11 offset:23552
    ds_read_b64_tr_b16 v[32:33], v12 offset:22528
    ds_read_b64_tr_b16 v[34:35], v12 offset:23552
    s_waitcnt lgkmcnt(0)
    v_mfma_f32_32x32x16_bf16 v[40:55], v[16:19], v[28:31], v[40:55]
    v_mfma_f32_32x32x16_bf16 v[56:71], v[16:19], v[32:35], v[56:71]
    s_waitcnt vmcnt(2)
    ds_read_b64_tr_b16 v[20:21], v11 offset:24576
    ds_read_b64_tr_b16 v[22:23], v11 offset:25600
    ds_read_b64_tr_b16 v[24:25], v12 offset:24576
    ds_read_b64_tr_b16 v[26:27], v12 offset:25600
    s_waitcnt lgkmcnt(0)
    v_mfma_f32_32x32x16_bf16 v[40:55], v[16:19], v[20:23], v[40:55]
    v_mfma_f32_32x32x16_bf16 v[56:71], v[16:19], v[24:27], v[56:71]
    s_waitcnt vmcnt(0)
    ds_read_b64_tr_b16 v[28:29], v11 offset:26624
    ds_read_b64_tr_b16 v[30:31], v11 offset:27648
    ds_read_b64_tr_b16 v[32:33], v12 offset:26624
    ds_read_b64_tr_b16 v[34:35], v12 offset:27648
    s_waitcnt lgkmcnt(0)
    v_mfma_f32_32x32x16_bf16 v[40:55], v[16:19], v[28:31], v[40:55]
    v_mfma_f32_32x32x16_bf16 v[56:71], v[16:19], v[32:35], v[56:71]
    v_cmp_gt_u32 vcc, 32, v1
    s_nop 11
    v_cndmask_b32 v40, v56, v40, vcc
    v_lshlrev_b32 v13, 2, v1
    s_sub_u32 s3, s66, 4
    s_lshl_b32 s3, s3, 8
    s_add_u32 s3, s3, 122880
    v_add_u32 v14, s3, v13
    ds_write_b32 v14, v40
    s_waitcnt lgkmcnt(0)
    s_barrier
    s_cmp_lg_u32 s67, 0
    s_cbranch_scc1 L_SP6
    ds_read_b32 v41, v14 offset:256
    s_waitcnt lgkmcnt(0)
    v_add_f32 v40, v40, v41
    s_sub_u32 s3, s66, 4
    s_lshr_b32 s3, s3, 1
    s_mul_i32 s3, s3, 7168
    s_lshl_b32 s4, s68, 8
    s_add_u32 s3, s3, s4
    s_add_u32 s3, s3, 14974976
    buffer_store_dword v40, v13, s[60:63], s3 offen sc0 sc1
    s_branch L_SP6
L_SPX:
    s_barrier
L_SP6:
    s_waitcnt vmcnt(0)
    s_barrier
    s_cmp_lg_u32 s66, 0
    s_cbranch_scc1 L_SP7
    v_mov_b32 v4, 1
    s_lshl_b32 s3, s64, 2
    v_mov_b32 v5, s3
    s_mov_b64 exec, 1
    buffer_store_dword v4, v5, s[12:15], 0 offen offset:128 sc0 sc1
    s_mov_b64 exec, -1
L_SP7:
L_END:
    s_endpgm
.section .rodata,"a"
.p2align 6
.amdhsa_kernel recurrent_scan__ssm_conv_s5__swiglu_ffn__prompt_kernel
  .amdhsa_next_free_vgpr 256
  .amdhsa_next_free_sgpr 102
  .amdhsa_accum_offset 256
  .amdhsa_group_segment_fixed_size 0
  .amdhsa_kernarg_size 128
  .amdhsa_user_sgpr_count 2
  .amdhsa_user_sgpr_kernarg_segment_ptr 1
  .amdhsa_system_sgpr_workgroup_id_x 1
  .amdhsa_float_denorm_mode_32 3
.end_amdhsa_kernel
```
